```python
import torch

def _softmax(x, axis=-1):
    return torch.softmax(x, dim=axis)
def _gelu(x):
    return torch.nn.functional.gelu(x, approximate="tanh")
def _silu(x):
    return torch.nn.functional.silu(x)
def _sigmoid(x):
    return torch.sigmoid(x)
def _layernorm(x, axis=-1, eps=1e-5):
    m = x.mean(dim=axis, keepdim=True)
    v = x.var(dim=axis, keepdim=True, unbiased=False)
    return (x - m) / torch.sqrt(v + eps)
def _scatter_add(tgt, idx, src, axis=0):
    return tgt.clone().index_add_(axis, idx, src)
def _segment_sum(src, seg, n):
    out = torch.zeros((n,) + src.shape[1:], dtype=src.dtype)
    return out.index_add_(0, seg, src)
def _pad(x, pw):
    flat = tuple(v for pair in reversed(pw) for v in pair)
    return torch.nn.functional.pad(x, flat)

kernel_name = 'sequential_preLN__gqa_block_cached__swiglu_ffn__decode'

def setup_inputs():

    _w = (lambda a: (lambda t: t.to(torch.bfloat16) if t.is_floating_point() else t)(torch.as_tensor(a)))
    def _A_setup():
        B, Sq, D = 4, 1, 512
        Hq, Hkv, Sk, Dh = 32, 8, 4096, 128
        assert Hq % Hkv == 0, (Hq, Hkv)
        return {
            "x": _w((lambda *s: torch.randn(*s, dtype=torch.bfloat16) * 0.05)(B, Sq, D)),
            "k_cache": _w((lambda *s: torch.randn(*s, dtype=torch.bfloat16) * 3.2)(B, Hkv, Sk, Dh)),
            "v_cache": _w((lambda *s: torch.randn(*s, dtype=torch.bfloat16) * 0.4)(B, Hkv, Sk, Dh)),
            "wq": _w((lambda *s: torch.randn(*s, dtype=torch.bfloat16) * 3.2)(D, Hq * Dh) * (D ** -0.5)),
            "wo": _w((lambda *s: torch.randn(*s, dtype=torch.bfloat16) * 0.4)(Hq * Dh, D) * ((Hq * Dh) ** -0.5)),
        }
    _A_in = _A_setup()

    def _B_setup():
        B, S, D, F = 4, 1, 512, 1792
        return {
            "x": _w((lambda *s: torch.randn(*s, dtype=torch.bfloat16) * 0.05)(B, S, D)),
            "w_gate": _w((lambda *s: torch.randn(*s, dtype=torch.bfloat16) * 0.05)(D, F)),
            "w_up": _w((lambda *s: torch.randn(*s, dtype=torch.bfloat16) * 0.05)(D, F)),
            "w_down": _w((lambda *s: torch.randn(*s, dtype=torch.bfloat16) * 0.05)(F, D)),
        }
    _B_in = _B_setup()

    return {
        "A_x": _A_in["x"],
        "A_k_cache": _A_in["k_cache"],
        "A_v_cache": _A_in["v_cache"],
        "A_wq": _A_in["wq"],
        "A_wo": _A_in["wo"],
        "B_x": _B_in["x"],
        "B_w_gate": _B_in["w_gate"],
        "B_w_up": _B_in["w_up"],
        "B_w_down": _B_in["w_down"],
    }

def reference(A_x, A_k_cache, A_v_cache, A_wq, A_wo, B_x, B_w_gate, B_w_up, B_w_down):
    def _A_ref(x, k_cache, v_cache, wq, wo):
        B, Sq, D = x.shape
        Hq, Dh = 32, 128
        Hkv = k_cache.shape[1]
        rep = Hq // Hkv
        q = (lambda x, *d: x.permute(*d))((x @ wq).reshape(B, Sq, Hq, Dh), 0, 2, 1, 3)
        k = (lambda x, n, axis: torch.repeat_interleave(x, n, dim=axis))(k_cache, rep, axis=1)
        v = (lambda x, n, axis: torch.repeat_interleave(x, n, dim=axis))(v_cache, rep, axis=1)
        scores = torch.einsum("bhqd,bhkd->bhqk", q, k) * (Dh ** -0.5)
        p = _softmax(scores, axis=-1)
        o = torch.einsum("bhqk,bhkd->bhqd", p, v)
        return (lambda x, *d: x.permute(*d))(o, 0, 2, 1, 3).reshape(B, Sq, Hq * Dh) @ wo

    def _B_ref(x, w_gate, w_up, w_down):
        g = _silu(x @ w_gate)
        u = x @ w_up
        return (g * u) @ w_down

    x = A_x
    h = x + _A_ref(_layernorm(x, axis=-1), A_k_cache, A_v_cache, A_wq, A_wo)
    h2 = h + _B_ref(_layernorm(h, axis=-1), B_w_gate, B_w_up, B_w_down)
    return h2
```

```asm
; @launch grid=(256,1,1) block=(512,1,1) lds=161280
.amdgcn_target "amdgcn-amd-amdhsa--gfx950"
.text
.globl sequential_preLN__gqa_block_cached__swiglu_ffn__decode_kernel
.p2align 8
.type sequential_preLN__gqa_block_cached__swiglu_ffn__decode_kernel,@function
sequential_preLN__gqa_block_cached__swiglu_ffn__decode_kernel:
    s_cmp_ge_u32 s2, 256
    s_cbranch_scc1 L_end
    s_load_dwordx16 s[48:63], s[0:1], 0
    s_load_dwordx8 s[64:71], s[0:1], 64
    v_lshrrev_b32 v2, 6, v0
    v_and_b32 v1, 63, v0
    s_and_b32 s37, s2, 7
    v_readfirstlane_b32 s36, v2
    s_lshr_b32 s38, s2, 3
    v_lshrrev_b32 v2, 4, v1
    v_bfe_u32 v3, v1, 2, 2
    v_and_b32 v4, 3, v1
    v_and_b32 v5, 15, v1
    s_mov_b32 s18, 0x10000000
    s_mov_b32 s19, 0x20000
    s_cmp_ge_u32 s38, 8
    s_cbranch_scc1 L_attn
    v_lshrrev_b32 v12, 3, v1
    v_and_b32 v13, 7, v1
    v_and_b32 v14, 2, v12
    v_xor_b32 v13, v13, v14
    v_xor_b32 v14, 4, v13
    v_lshlrev_b32 v13, 4, v13
    v_lshlrev_b32 v14, 4, v14
    v_lshl_add_u32 v15, v12, 13, v13
    v_lshl_add_u32 v16, v12, 13, v14
    s_lshl_b32 s40, s36, 14
    s_add_u32 s40, s40, 30208
    s_lshl_b32 s42, s37, 10
    s_lshl_b32 s46, s38, 7
    s_add_u32 s42, s42, s46
    s_lshl_b32 s46, s36, 19
    s_add_u32 s42, s42, s46
    s_mov_b32 s46, s40
    s_mov_b32 s22, 0x400000
    s_mov_b32 s23, 0x20000
    s_waitcnt lgkmcnt(0)
    s_mov_b32 s20, s54
    s_mov_b32 s21, s55
    s_load_dword s39, s[70:71], 0
    s_mov_b32 m0, s46
    s_add_u32 s46, s46, 1024
    buffer_load_dwordx4 v15, s[20:23], s42 offen nt lds
    s_add_u32 s42, s42, 65536
    s_mov_b32 m0, s46
    s_add_u32 s46, s46, 1024
    buffer_load_dwordx4 v16, s[20:23], s42 offen nt lds
    s_add_u32 s42, s42, 65536
    s_mov_b32 m0, s46
    s_add_u32 s46, s46, 1024
    buffer_load_dwordx4 v15, s[20:23], s42 offen nt lds
    s_add_u32 s42, s42, 65536
    s_mov_b32 m0, s46
    s_add_u32 s46, s46, 1024
    buffer_load_dwordx4 v16, s[20:23], s42 offen nt lds
    s_add_u32 s42, s42, 65536
    s_mov_b32 m0, s46
    s_add_u32 s46, s46, 1024
    buffer_load_dwordx4 v15, s[20:23], s42 offen nt lds
    s_add_u32 s42, s42, 65536
    s_mov_b32 m0, s46
    s_add_u32 s46, s46, 1024
    buffer_load_dwordx4 v16, s[20:23], s42 offen nt lds
    s_add_u32 s42, s42, 65536
    s_mov_b32 m0, s46
    s_add_u32 s46, s46, 1024
    buffer_load_dwordx4 v15, s[20:23], s42 offen nt lds
    s_add_u32 s42, s42, 65536
    s_mov_b32 m0, s46
    s_add_u32 s46, s46, 1024
    buffer_load_dwordx4 v16, s[20:23], s42 offen nt lds
    s_add_u32 s42, s42, 65536
    s_branch L_service
L_attn:
    s_sub_u32 s38, s38, 8
    s_cmp_lg_u32 s36, 7
    s_cbranch_scc1 L_nopref
    s_getpc_b64 s[4:5]
L_pc:
    s_sub_u32 s4, s4, L_pc-sequential_preLN__gqa_block_cached__swiglu_ffn__decode_kernel
    s_subb_u32 s5, s5, 0
    s_lshl_b32 s41, s38, 10
    v_lshl_add_u32 v52, v1, 7, s41
    v_min_u32 v52, L_codeend-sequential_preLN__gqa_block_cached__swiglu_ffn__decode_kernel-4, v52
    s_mov_b64 exec, 0xff
    global_load_dword v17, v52, s[4:5]
    s_mov_b64 exec, -1
L_nopref:
    s_mul_i32 s45, s38, 43
    s_lshr_b32 s45, s45, 8
    s_mul_i32 s41, s45, 6
    s_sub_u32 s41, s38, s41
    s_mul_i32 s42, s36, 6
    s_add_u32 s41, s41, s42
    s_min_u32 s42, s41, 16
    s_mul_i32 s40, s41, 21
    s_add_u32 s40, s40, s42
    s_lshl_b32 s42, s45, 3
    s_or_b32 s42, s42, s37
    s_lshl_b32 s42, s42, 10
    s_add_u32 s40, s40, s42
    s_lshl_b32 s40, s40, 10
    s_add_u32 s47, s40, 21504
    s_cmp_lt_u32 s41, 16
    s_cselect_b32 s47, s47, 0x40000000
    s_cselect_b32 s3, 0, 0xff800000
    v_lshlrev_b32 v7, 4, v1
    v_lshlrev_b32 v6, 6, v2
    v_lshl_add_u32 v6, v3, 8, v6
    v_lshl_add_u32 v6, v4, 4, v6
    s_mov_b32 s10, 0x2000000
    s_mov_b32 s11, 0x20000
    s_mov_b32 s14, 0x2000000
    s_mov_b32 s15, 0x20000
    s_waitcnt lgkmcnt(0)
    s_mov_b32 s8, s50
    s_mov_b32 s9, s51
    s_mov_b32 s12, s52
    s_mov_b32 s13, s53
    s_mov_b32 s16, s70
    s_mov_b32 s17, s71
    s_load_dword s39, s[70:71], 0
    s_cmp_lg_u32 s36, 7
    s_cbranch_scc1 L_kload
    s_setprio 3
    s_getreg_b32 s42, hwreg(HW_REG_XCC_ID, 0, 4)
    s_lshl_b32 s46, s37, 5
    s_add_u32 s46, s46, s38
    s_lshl_b32 s46, s46, 3
    s_add_u32 s46, s46, 8256
    v_mov_b32 v53, s42
    s_waitcnt lgkmcnt(0)
    s_add_u32 s42, s39, 0x1010101
    v_mov_b32 v52, s42
    s_mov_b64 exec, 1
    buffer_store_dwordx2 v[52:53], v7, s[16:19], s46 offen sc1
    s_mov_b64 exec, -1
    s_setprio 0
L_kload:
    s_cmp_ge_u32 s36, 4
    s_cbranch_scc1 L_late
    s_add_u32 s41, s40, 0
    buffer_load_dwordx4 v[74:77], v6, s[8:11], s41 offen offset:0 nt
    buffer_load_dwordx4 v[78:81], v6, s[8:11], s41 offen offset:1024 nt
    buffer_load_dwordx4 v[82:85], v6, s[8:11], s41 offen offset:2048 nt
    buffer_load_dwordx4 v[86:89], v6, s[8:11], s41 offen offset:3072 nt
    s_add_u32 s41, s40, 4096
    buffer_load_dwordx4 v[90:93], v6, s[8:11], s41 offen offset:0 nt
    s_waitcnt vmcnt(4)
    buffer_load_dwordx4 v[94:97], v6, s[8:11], s41 offen offset:1024 nt
    s_waitcnt vmcnt(4)
    buffer_load_dwordx4 v[98:101], v6, s[8:11], s41 offen offset:2048 nt
    s_waitcnt vmcnt(4)
    buffer_load_dwordx4 v[102:105], v6, s[8:11], s41 offen offset:3072 nt
    s_waitcnt vmcnt(4)
    s_add_u32 s41, s40, 8192
    buffer_load_dwordx4 v[106:109], v6, s[8:11], s41 offen offset:0 nt
    s_waitcnt vmcnt(4)
    buffer_load_dwordx4 v[110:113], v6, s[8:11], s41 offen offset:1024 nt
    s_waitcnt vmcnt(4)
    buffer_load_dwordx4 v[114:117], v6, s[8:11], s41 offen offset:2048 nt
    s_waitcnt vmcnt(4)
    buffer_load_dwordx4 v[118:121], v6, s[8:11], s41 offen offset:3072 nt
    s_waitcnt vmcnt(4)
    s_add_u32 s41, s40, 12288
    buffer_load_dwordx4 v[122:125], v6, s[8:11], s41 offen offset:0 nt
    s_waitcnt vmcnt(4)
    buffer_load_dwordx4 v[126:129], v6, s[8:11], s41 offen offset:1024 nt
    s_waitcnt vmcnt(4)
    buffer_load_dwordx4 v[130:133], v6, s[8:11], s41 offen offset:2048 nt
    s_waitcnt vmcnt(4)
    buffer_load_dwordx4 v[134:137], v6, s[8:11], s41 offen offset:3072 nt
    s_waitcnt vmcnt(4)
    s_add_u32 s41, s40, 16384
    buffer_load_dwordx4 v[138:141], v6, s[8:11], s41 offen offset:0 nt
    s_waitcnt vmcnt(4)
    buffer_load_dwordx4 v[142:145], v6, s[8:11], s41 offen offset:1024 nt
    s_waitcnt vmcnt(4)
    buffer_load_dwordx4 v[146:149], v6, s[8:11], s41 offen offset:2048 nt
    s_waitcnt vmcnt(4)
    buffer_load_dwordx4 v[150:153], v6, s[8:11], s41 offen offset:3072 nt
    s_waitcnt vmcnt(4)
    s_add_u32 s41, s40, 20480
    buffer_load_dwordx4 v[154:157], v6, s[8:11], s41 offen offset:0 nt
    s_waitcnt vmcnt(4)
    buffer_load_dwordx4 v[70:73], v6, s[8:11], s47 offen nt
    s_waitcnt vmcnt(4)
    s_add_u32 s41, s40, 0
    buffer_load_dwordx4 v[162:165], v7, s[12:15], s41 offen offset:0 nt
    s_waitcnt vmcnt(4)
    buffer_load_dwordx4 v[166:169], v7, s[12:15], s41 offen offset:1024 nt
    s_waitcnt vmcnt(4)
    buffer_load_dwordx4 v[170:173], v7, s[12:15], s41 offen offset:2048 nt
    s_waitcnt vmcnt(4)
    buffer_load_dwordx4 v[174:177], v7, s[12:15], s41 offen offset:3072 nt
    s_waitcnt vmcnt(4)
    s_add_u32 s41, s40, 4096
    buffer_load_dwordx4 v[178:181], v7, s[12:15], s41 offen offset:0 nt
    s_waitcnt vmcnt(4)
    buffer_load_dwordx4 v[182:185], v7, s[12:15], s41 offen offset:1024 nt
    s_barrier
    buffer_load_dwordx4 v[186:189], v7, s[12:15], s41 offen offset:2048 nt
    buffer_load_dwordx4 v[190:193], v7, s[12:15], s41 offen offset:3072 nt
    s_add_u32 s41, s40, 8192
    buffer_load_dwordx4 v[194:197], v7, s[12:15], s41 offen offset:0 nt
    buffer_load_dwordx4 v[198:201], v7, s[12:15], s41 offen offset:1024 nt
    buffer_load_dwordx4 v[202:205], v7, s[12:15], s41 offen offset:2048 nt
    buffer_load_dwordx4 v[206:209], v7, s[12:15], s41 offen offset:3072 nt
    s_add_u32 s41, s40, 12288
    buffer_load_dwordx4 v[210:213], v7, s[12:15], s41 offen offset:0 nt
    buffer_load_dwordx4 v[214:217], v7, s[12:15], s41 offen offset:1024 nt
    buffer_load_dwordx4 v[218:221], v7, s[12:15], s41 offen offset:2048 nt
    buffer_load_dwordx4 v[222:225], v7, s[12:15], s41 offen offset:3072 nt
    s_add_u32 s41, s40, 16384
    buffer_load_dwordx4 v[226:229], v7, s[12:15], s41 offen offset:0 nt
    buffer_load_dwordx4 v[230:233], v7, s[12:15], s41 offen offset:1024 nt
    buffer_load_dwordx4 v[234:237], v7, s[12:15], s41 offen offset:2048 nt
    buffer_load_dwordx4 v[238:241], v7, s[12:15], s41 offen offset:3072 nt
    s_add_u32 s41, s40, 20480
    buffer_load_dwordx4 v[242:245], v7, s[12:15], s41 offen offset:0 nt
    buffer_load_dwordx4 v[158:161], v7, s[12:15], s47 offen nt
    s_lshl_b32 s42, s45, 14
    s_lshl_b32 s46, s37, 11
    s_add_u32 s42, s42, s46
    s_add_u32 s42, s42, 65536
    s_lshl_b32 s44, s45, 1
    s_add_u32 s44, s44, s38
    s_and_b32 s46, s44, 16
    s_add_u32 s44, s44, s46
    s_lshl_b32 s44, s44, 6
    s_lshl_b32 s46, s37, 15
    s_add_u32 s44, s44, s46
    s_add_u32 s44, s44, 262144
    v_mov_b32 v9, 0x3e0293ee
    v_mov_b32 v60, 0x0c0c0c0c
    v_mov_b32 v61, 0x0c0c0100
    v_mov_b32 v62, 0x01000c0c
    v_mov_b32 v63, 0x0c0c0302
    v_mov_b32 v64, 0x03020c0c
    v_cmp_eq_u32 s[4:5], 0, v4
    v_cmp_eq_u32 s[6:7], 1, v4
    s_nop 1
    v_cndmask_b32 v13, v60, v61, s[4:5]
    v_cndmask_b32 v13, v13, v62, s[6:7]
    v_cndmask_b32 v14, v60, v63, s[4:5]
    v_cndmask_b32 v14, v14, v64, s[6:7]
    v_cmp_eq_u32 s[4:5], 2, v4
    v_cmp_eq_u32 s[6:7], 3, v4
    s_nop 1
    v_cndmask_b32 v15, v60, v61, s[4:5]
    v_cndmask_b32 v15, v15, v62, s[6:7]
    v_cndmask_b32 v16, v60, v63, s[4:5]
    v_cndmask_b32 v16, v16, v64, s[6:7]
    s_lshl_b32 s6, s36, 2
    s_add_u32 s6, s6, 0
    s_mul_i32 s7, s36, 2304
    s_add_u32 s7, s7, 256
    v_and_b32 v8, 7, v1
    v_lshlrev_b32 v8, 2, v8
    s_lshl_b32 s46, s37, 7
    s_add_u32 s46, s46, 4096
    s_waitcnt lgkmcnt(0)
    s_add_u32 s39, s39, 0x1010101
    s_mov_b32 s43, 0
    s_branch L_qp
L_late:
    v_mov_b32 v70, 0
    v_mov_b32 v158, 0
    v_mov_b32 v71, 0
    v_mov_b32 v159, 0
    v_mov_b32 v72, 0
    v_mov_b32 v160, 0
    v_mov_b32 v73, 0
    v_mov_b32 v161, 0
    s_lshl_b32 s42, s45, 14
    s_lshl_b32 s46, s37, 11
    s_add_u32 s42, s42, s46
    s_add_u32 s42, s42, 65536
    s_lshl_b32 s44, s45, 1
    s_add_u32 s44, s44, s38
    s_and_b32 s46, s44, 16
    s_add_u32 s44, s44, s46
    s_lshl_b32 s44, s44, 6
    s_lshl_b32 s46, s37, 15
    s_add_u32 s44, s44, s46
    s_add_u32 s44, s44, 262144
    v_mov_b32 v9, 0x3e0293ee
    v_mov_b32 v60, 0x0c0c0c0c
    v_mov_b32 v61, 0x0c0c0100
    v_mov_b32 v62, 0x01000c0c
    v_mov_b32 v63, 0x0c0c0302
    v_mov_b32 v64, 0x03020c0c
    v_cmp_eq_u32 s[4:5], 0, v4
    v_cmp_eq_u32 s[6:7], 1, v4
    s_nop 1
    v_cndmask_b32 v13, v60, v61, s[4:5]
    v_cndmask_b32 v13, v13, v62, s[6:7]
    v_cndmask_b32 v14, v60, v63, s[4:5]
    v_cndmask_b32 v14, v14, v64, s[6:7]
    v_cmp_eq_u32 s[4:5], 2, v4
    v_cmp_eq_u32 s[6:7], 3, v4
    s_nop 1
    v_cndmask_b32 v15, v60, v61, s[4:5]
    v_cndmask_b32 v15, v15, v62, s[6:7]
    v_cndmask_b32 v16, v60, v63, s[4:5]
    v_cndmask_b32 v16, v16, v64, s[6:7]
    s_lshl_b32 s6, s36, 2
    s_add_u32 s6, s6, 0
    s_mul_i32 s7, s36, 2304
    s_add_u32 s7, s7, 256
    v_and_b32 v8, 7, v1
    v_lshlrev_b32 v8, 2, v8
    s_lshl_b32 s46, s37, 7
    s_add_u32 s46, s46, 4096
    s_waitcnt lgkmcnt(0)
    s_add_u32 s39, s39, 0x1010101
    s_mov_b32 s43, 0
    s_barrier
    s_add_u32 s41, s40, 0
    buffer_load_dwordx4 v[74:77], v6, s[8:11], s41 offen offset:0 nt
    buffer_load_dwordx4 v[78:81], v6, s[8:11], s41 offen offset:1024 nt
    buffer_load_dwordx4 v[82:85], v6, s[8:11], s41 offen offset:2048 nt
    buffer_load_dwordx4 v[86:89], v6, s[8:11], s41 offen offset:3072 nt
    s_add_u32 s41, s40, 4096
    buffer_load_dwordx4 v[90:93], v6, s[8:11], s41 offen offset:0 nt
    buffer_load_dwordx4 v[94:97], v6, s[8:11], s41 offen offset:1024 nt
    buffer_load_dwordx4 v[98:101], v6, s[8:11], s41 offen offset:2048 nt
    buffer_load_dwordx4 v[102:105], v6, s[8:11], s41 offen offset:3072 nt
    s_add_u32 s41, s40, 8192
    buffer_load_dwordx4 v[106:109], v6, s[8:11], s41 offen offset:0 nt
    buffer_load_dwordx4 v[110:113], v6, s[8:11], s41 offen offset:1024 nt
    buffer_load_dwordx4 v[114:117], v6, s[8:11], s41 offen offset:2048 nt
    buffer_load_dwordx4 v[118:121], v6, s[8:11], s41 offen offset:3072 nt
    s_add_u32 s41, s40, 12288
    buffer_load_dwordx4 v[122:125], v6, s[8:11], s41 offen offset:0 nt
    buffer_load_dwordx4 v[126:129], v6, s[8:11], s41 offen offset:1024 nt
    buffer_load_dwordx4 v[130:133], v6, s[8:11], s41 offen offset:2048 nt
    buffer_load_dwordx4 v[134:137], v6, s[8:11], s41 offen offset:3072 nt
    s_add_u32 s41, s40, 16384
    buffer_load_dwordx4 v[138:141], v6, s[8:11], s41 offen offset:0 nt
    buffer_load_dwordx4 v[142:145], v6, s[8:11], s41 offen offset:1024 nt
    buffer_load_dwordx4 v[146:149], v6, s[8:11], s41 offen offset:2048 nt
    buffer_load_dwordx4 v[150:153], v6, s[8:11], s41 offen offset:3072 nt
    s_add_u32 s41, s40, 20480
    buffer_load_dwordx4 v[154:157], v6, s[8:11], s41 offen offset:0 nt
    buffer_load_dwordx4 v[30:33], v6, s[16:19], s42 offen sc1
    buffer_load_dwordx4 v[34:37], v6, s[16:19], s42 offen offset:1024 sc1
    s_add_u32 s41, s40, 0
    buffer_load_dwordx4 v[162:165], v7, s[12:15], s41 offen offset:0 nt
    buffer_load_dwordx4 v[166:169], v7, s[12:15], s41 offen offset:1024 nt
    buffer_load_dwordx4 v[170:173], v7, s[12:15], s41 offen offset:2048 nt
    buffer_load_dwordx4 v[174:177], v7, s[12:15], s41 offen offset:3072 nt
    s_add_u32 s41, s40, 4096
    buffer_load_dwordx4 v[178:181], v7, s[12:15], s41 offen offset:0 nt
    buffer_load_dwordx4 v[182:185], v7, s[12:15], s41 offen offset:1024 nt
    buffer_load_dwordx4 v[186:189], v7, s[12:15], s41 offen offset:2048 nt
    buffer_load_dwordx4 v[190:193], v7, s[12:15], s41 offen offset:3072 nt
    s_waitcnt vmcnt(8)
    v_xor_b32 v52, s39, v31
    v_xor_b32 v53, s39, v33
    v_xor_b32 v54, s39, v35
    v_xor_b32 v55, s39, v37
    v_or_b32 v52, v52, v53
    v_or3_b32 v52, v52, v54, v55
    v_cmp_ne_u32 vcc, 0, v52
    v_mov_b32 v18, v30
    v_mov_b32 v19, v32
    v_mov_b32 v20, v34
    v_mov_b32 v21, v36
    s_cbranch_vccz L_inter
    s_add_u32 s41, s40, 8192
    buffer_load_dwordx4 v[194:197], v7, s[12:15], s41 offen offset:0 nt
    buffer_load_dwordx4 v[198:201], v7, s[12:15], s41 offen offset:1024 nt
    buffer_load_dwordx4 v[202:205], v7, s[12:15], s41 offen offset:2048 nt
    buffer_load_dwordx4 v[206:209], v7, s[12:15], s41 offen offset:3072 nt
    s_add_u32 s41, s40, 12288
    buffer_load_dwordx4 v[210:213], v7, s[12:15], s41 offen offset:0 nt
    buffer_load_dwordx4 v[214:217], v7, s[12:15], s41 offen offset:1024 nt
    buffer_load_dwordx4 v[218:221], v7, s[12:15], s41 offen offset:2048 nt
    buffer_load_dwordx4 v[222:225], v7, s[12:15], s41 offen offset:3072 nt
    s_add_u32 s41, s40, 16384
    buffer_load_dwordx4 v[226:229], v7, s[12:15], s41 offen offset:0 nt
    buffer_load_dwordx4 v[230:233], v7, s[12:15], s41 offen offset:1024 nt
    buffer_load_dwordx4 v[234:237], v7, s[12:15], s41 offen offset:2048 nt
    buffer_load_dwordx4 v[238:241], v7, s[12:15], s41 offen offset:3072 nt
    s_add_u32 s41, s40, 20480
    buffer_load_dwordx4 v[242:245], v7, s[12:15], s41 offen offset:0 nt
L_qp:
    s_mov_b64 vcc, -1
L_qpoll:
    s_mov_b64 exec, vcc
    buffer_load_dwordx4 v[30:33], v6, s[16:19], s42 offen sc1
    buffer_load_dwordx4 v[34:37], v6, s[16:19], s42 offen offset:1024 sc1
    s_mov_b64 exec, -1
    s_waitcnt vmcnt(0)
    v_xor_b32 v52, s39, v31
    v_xor_b32 v53, s39, v33
    v_xor_b32 v54, s39, v35
    v_xor_b32 v55, s39, v37
    v_or_b32 v52, v52, v53
    v_or3_b32 v52, v52, v54, v55
    v_cmp_ne_u32 vcc, 0, v52
    v_mov_b32 v18, v30
    v_mov_b32 v19, v32
    v_mov_b32 v20, v34
    v_mov_b32 v21, v36
    s_add_u32 s43, s43, 1
    s_cmp_gt_u32 s43, 400000
    s_cbranch_scc1 L_qok
    s_cbranch_vccnz L_qpoll
L_qok:
    buffer_load_dword v17, v8, s[16:19], s46 offen sc1
    s_nop 1
    v_mfma_f32_16x16x32_bf16 v[52:55], v[70:73], v[18:21], 0
    v_mfma_f32_16x16x32_bf16 v[56:59], v[74:77], v[18:21], 0
    v_mfma_f32_16x16x32_bf16 v[60:63], v[78:81], v[18:21], 0
    s_nop 5
    v_mfma_f32_16x16x32_bf16 v[64:67], v[82:85], v[18:21], 0
    v_mul_f32_dpp v30, v52, v9 quad_perm:[0,0,0,0] row_mask:0xf bank_mask:0xf
    v_fmac_f32_dpp v30, v53, v9 quad_perm:[1,1,1,1] row_mask:0xf bank_mask:0xf
    v_fmac_f32_dpp v30, v54, v9 quad_perm:[2,2,2,2] row_mask:0xf bank_mask:0xf
    v_fmac_f32_dpp v30, v55, v9 quad_perm:[3,3,3,3] row_mask:0xf bank_mask:0xf
    v_mfma_f32_16x16x32_bf16 v[52:55], v[86:89], v[18:21], 0
    v_mul_f32_dpp v31, v56, v9 quad_perm:[0,0,0,0] row_mask:0xf bank_mask:0xf
    v_fmac_f32_dpp v31, v57, v9 quad_perm:[1,1,1,1] row_mask:0xf bank_mask:0xf
    v_fmac_f32_dpp v31, v58, v9 quad_perm:[2,2,2,2] row_mask:0xf bank_mask:0xf
    v_fmac_f32_dpp v31, v59, v9 quad_perm:[3,3,3,3] row_mask:0xf bank_mask:0xf
    v_mfma_f32_16x16x32_bf16 v[56:59], v[90:93], v[18:21], 0
    v_mul_f32_dpp v32, v60, v9 quad_perm:[0,0,0,0] row_mask:0xf bank_mask:0xf
    v_fmac_f32_dpp v32, v61, v9 quad_perm:[1,1,1,1] row_mask:0xf bank_mask:0xf
    v_fmac_f32_dpp v32, v62, v9 quad_perm:[2,2,2,2] row_mask:0xf bank_mask:0xf
    v_fmac_f32_dpp v32, v63, v9 quad_perm:[3,3,3,3] row_mask:0xf bank_mask:0xf
    v_mfma_f32_16x16x32_bf16 v[60:63], v[94:97], v[18:21], 0
    v_mul_f32_dpp v33, v64, v9 quad_perm:[0,0,0,0] row_mask:0xf bank_mask:0xf
    v_fmac_f32_dpp v33, v65, v9 quad_perm:[1,1,1,1] row_mask:0xf bank_mask:0xf
    v_fmac_f32_dpp v33, v66, v9 quad_perm:[2,2,2,2] row_mask:0xf bank_mask:0xf
    v_fmac_f32_dpp v33, v67, v9 quad_perm:[3,3,3,3] row_mask:0xf bank_mask:0xf
    v_mfma_f32_16x16x32_bf16 v[64:67], v[98:101], v[18:21], 0
    v_mul_f32_dpp v34, v52, v9 quad_perm:[0,0,0,0] row_mask:0xf bank_mask:0xf
    v_fmac_f32_dpp v34, v53, v9 quad_perm:[1,1,1,1] row_mask:0xf bank_mask:0xf
    v_fmac_f32_dpp v34, v54, v9 quad_perm:[2,2,2,2] row_mask:0xf bank_mask:0xf
    v_fmac_f32_dpp v34, v55, v9 quad_perm:[3,3,3,3] row_mask:0xf bank_mask:0xf
    v_mfma_f32_16x16x32_bf16 v[52:55], v[102:105], v[18:21], 0
    v_mul_f32_dpp v35, v56, v9 quad_perm:[0,0,0,0] row_mask:0xf bank_mask:0xf
    v_fmac_f32_dpp v35, v57, v9 quad_perm:[1,1,1,1] row_mask:0xf bank_mask:0xf
    v_fmac_f32_dpp v35, v58, v9 quad_perm:[2,2,2,2] row_mask:0xf bank_mask:0xf
    v_fmac_f32_dpp v35, v59, v9 quad_perm:[3,3,3,3] row_mask:0xf bank_mask:0xf
    v_mfma_f32_16x16x32_bf16 v[56:59], v[106:109], v[18:21], 0
    v_mul_f32_dpp v36, v60, v9 quad_perm:[0,0,0,0] row_mask:0xf bank_mask:0xf
    v_fmac_f32_dpp v36, v61, v9 quad_perm:[1,1,1,1] row_mask:0xf bank_mask:0xf
    v_fmac_f32_dpp v36, v62, v9 quad_perm:[2,2,2,2] row_mask:0xf bank_mask:0xf
    v_fmac_f32_dpp v36, v63, v9 quad_perm:[3,3,3,3] row_mask:0xf bank_mask:0xf
    v_mfma_f32_16x16x32_bf16 v[60:63], v[110:113], v[18:21], 0
    v_mul_f32_dpp v37, v64, v9 quad_perm:[0,0,0,0] row_mask:0xf bank_mask:0xf
    v_fmac_f32_dpp v37, v65, v9 quad_perm:[1,1,1,1] row_mask:0xf bank_mask:0xf
    v_fmac_f32_dpp v37, v66, v9 quad_perm:[2,2,2,2] row_mask:0xf bank_mask:0xf
    v_fmac_f32_dpp v37, v67, v9 quad_perm:[3,3,3,3] row_mask:0xf bank_mask:0xf
    v_mfma_f32_16x16x32_bf16 v[64:67], v[114:117], v[18:21], 0
    v_mul_f32_dpp v38, v52, v9 quad_perm:[0,0,0,0] row_mask:0xf bank_mask:0xf
    v_fmac_f32_dpp v38, v53, v9 quad_perm:[1,1,1,1] row_mask:0xf bank_mask:0xf
    v_fmac_f32_dpp v38, v54, v9 quad_perm:[2,2,2,2] row_mask:0xf bank_mask:0xf
    v_fmac_f32_dpp v38, v55, v9 quad_perm:[3,3,3,3] row_mask:0xf bank_mask:0xf
    v_mfma_f32_16x16x32_bf16 v[52:55], v[118:121], v[18:21], 0
    v_mul_f32_dpp v39, v56, v9 quad_perm:[0,0,0,0] row_mask:0xf bank_mask:0xf
    v_fmac_f32_dpp v39, v57, v9 quad_perm:[1,1,1,1] row_mask:0xf bank_mask:0xf
    v_fmac_f32_dpp v39, v58, v9 quad_perm:[2,2,2,2] row_mask:0xf bank_mask:0xf
    v_fmac_f32_dpp v39, v59, v9 quad_perm:[3,3,3,3] row_mask:0xf bank_mask:0xf
    v_mfma_f32_16x16x32_bf16 v[56:59], v[122:125], v[18:21], 0
    v_mul_f32_dpp v40, v60, v9 quad_perm:[0,0,0,0] row_mask:0xf bank_mask:0xf
    v_fmac_f32_dpp v40, v61, v9 quad_perm:[1,1,1,1] row_mask:0xf bank_mask:0xf
    v_fmac_f32_dpp v40, v62, v9 quad_perm:[2,2,2,2] row_mask:0xf bank_mask:0xf
    v_fmac_f32_dpp v40, v63, v9 quad_perm:[3,3,3,3] row_mask:0xf bank_mask:0xf
    v_mfma_f32_16x16x32_bf16 v[60:63], v[126:129], v[18:21], 0
    v_mul_f32_dpp v41, v64, v9 quad_perm:[0,0,0,0] row_mask:0xf bank_mask:0xf
    v_fmac_f32_dpp v41, v65, v9 quad_perm:[1,1,1,1] row_mask:0xf bank_mask:0xf
    v_fmac_f32_dpp v41, v66, v9 quad_perm:[2,2,2,2] row_mask:0xf bank_mask:0xf
    v_fmac_f32_dpp v41, v67, v9 quad_perm:[3,3,3,3] row_mask:0xf bank_mask:0xf
    v_mfma_f32_16x16x32_bf16 v[64:67], v[130:133], v[18:21], 0
    v_mul_f32_dpp v42, v52, v9 quad_perm:[0,0,0,0] row_mask:0xf bank_mask:0xf
    v_fmac_f32_dpp v42, v53, v9 quad_perm:[1,1,1,1] row_mask:0xf bank_mask:0xf
    v_fmac_f32_dpp v42, v54, v9 quad_perm:[2,2,2,2] row_mask:0xf bank_mask:0xf
    v_fmac_f32_dpp v42, v55, v9 quad_perm:[3,3,3,3] row_mask:0xf bank_mask:0xf
    v_mfma_f32_16x16x32_bf16 v[52:55], v[134:137], v[18:21], 0
    v_mul_f32_dpp v43, v56, v9 quad_perm:[0,0,0,0] row_mask:0xf bank_mask:0xf
    v_fmac_f32_dpp v43, v57, v9 quad_perm:[1,1,1,1] row_mask:0xf bank_mask:0xf
    v_fmac_f32_dpp v43, v58, v9 quad_perm:[2,2,2,2] row_mask:0xf bank_mask:0xf
    v_fmac_f32_dpp v43, v59, v9 quad_perm:[3,3,3,3] row_mask:0xf bank_mask:0xf
    v_mfma_f32_16x16x32_bf16 v[56:59], v[138:141], v[18:21], 0
    v_mul_f32_dpp v44, v60, v9 quad_perm:[0,0,0,0] row_mask:0xf bank_mask:0xf
    v_fmac_f32_dpp v44, v61, v9 quad_perm:[1,1,1,1] row_mask:0xf bank_mask:0xf
    v_fmac_f32_dpp v44, v62, v9 quad_perm:[2,2,2,2] row_mask:0xf bank_mask:0xf
    v_fmac_f32_dpp v44, v63, v9 quad_perm:[3,3,3,3] row_mask:0xf bank_mask:0xf
    v_mfma_f32_16x16x32_bf16 v[60:63], v[142:145], v[18:21], 0
    v_mul_f32_dpp v45, v64, v9 quad_perm:[0,0,0,0] row_mask:0xf bank_mask:0xf
    v_fmac_f32_dpp v45, v65, v9 quad_perm:[1,1,1,1] row_mask:0xf bank_mask:0xf
    v_fmac_f32_dpp v45, v66, v9 quad_perm:[2,2,2,2] row_mask:0xf bank_mask:0xf
    v_fmac_f32_dpp v45, v67, v9 quad_perm:[3,3,3,3] row_mask:0xf bank_mask:0xf
    v_mfma_f32_16x16x32_bf16 v[64:67], v[146:149], v[18:21], 0
    v_mul_f32_dpp v46, v52, v9 quad_perm:[0,0,0,0] row_mask:0xf bank_mask:0xf
    v_fmac_f32_dpp v46, v53, v9 quad_perm:[1,1,1,1] row_mask:0xf bank_mask:0xf
    v_fmac_f32_dpp v46, v54, v9 quad_perm:[2,2,2,2] row_mask:0xf bank_mask:0xf
    v_fmac_f32_dpp v46, v55, v9 quad_perm:[3,3,3,3] row_mask:0xf bank_mask:0xf
    v_mfma_f32_16x16x32_bf16 v[52:55], v[150:153], v[18:21], 0
    v_mul_f32_dpp v47, v56, v9 quad_perm:[0,0,0,0] row_mask:0xf bank_mask:0xf
    v_fmac_f32_dpp v47, v57, v9 quad_perm:[1,1,1,1] row_mask:0xf bank_mask:0xf
    v_fmac_f32_dpp v47, v58, v9 quad_perm:[2,2,2,2] row_mask:0xf bank_mask:0xf
    v_fmac_f32_dpp v47, v59, v9 quad_perm:[3,3,3,3] row_mask:0xf bank_mask:0xf
    v_mfma_f32_16x16x32_bf16 v[56:59], v[154:157], v[18:21], 0
    v_mul_f32_dpp v48, v60, v9 quad_perm:[0,0,0,0] row_mask:0xf bank_mask:0xf
    v_fmac_f32_dpp v48, v61, v9 quad_perm:[1,1,1,1] row_mask:0xf bank_mask:0xf
    v_fmac_f32_dpp v48, v62, v9 quad_perm:[2,2,2,2] row_mask:0xf bank_mask:0xf
    v_fmac_f32_dpp v48, v63, v9 quad_perm:[3,3,3,3] row_mask:0xf bank_mask:0xf
    s_nop 0
    v_mul_f32_dpp v49, v64, v9 quad_perm:[0,0,0,0] row_mask:0xf bank_mask:0xf
    v_fmac_f32_dpp v49, v65, v9 quad_perm:[1,1,1,1] row_mask:0xf bank_mask:0xf
    v_fmac_f32_dpp v49, v66, v9 quad_perm:[2,2,2,2] row_mask:0xf bank_mask:0xf
    v_fmac_f32_dpp v49, v67, v9 quad_perm:[3,3,3,3] row_mask:0xf bank_mask:0xf
    s_nop 0
    v_mul_f32_dpp v50, v52, v9 quad_perm:[0,0,0,0] row_mask:0xf bank_mask:0xf
    v_fmac_f32_dpp v50, v53, v9 quad_perm:[1,1,1,1] row_mask:0xf bank_mask:0xf
    v_fmac_f32_dpp v50, v54, v9 quad_perm:[2,2,2,2] row_mask:0xf bank_mask:0xf
    v_fmac_f32_dpp v50, v55, v9 quad_perm:[3,3,3,3] row_mask:0xf bank_mask:0xf
    s_nop 0
    v_mul_f32_dpp v51, v56, v9 quad_perm:[0,0,0,0] row_mask:0xf bank_mask:0xf
    v_fmac_f32_dpp v51, v57, v9 quad_perm:[1,1,1,1] row_mask:0xf bank_mask:0xf
    v_fmac_f32_dpp v51, v58, v9 quad_perm:[2,2,2,2] row_mask:0xf bank_mask:0xf
    v_fmac_f32_dpp v51, v59, v9 quad_perm:[3,3,3,3] row_mask:0xf bank_mask:0xf
    v_add_f32 v30, s3, v30
    v_max3_f32 v10, v31, v32, v33
    v_max3_f32 v10, v10, v34, v35
    v_max3_f32 v10, v10, v36, v37
    v_max3_f32 v10, v10, v38, v39
    v_max3_f32 v10, v10, v40, v41
    v_max3_f32 v10, v10, v42, v43
    v_max3_f32 v10, v10, v44, v45
    v_max3_f32 v10, v10, v46, v47
    v_max3_f32 v10, v10, v48, v49
    v_max3_f32 v10, v10, v50, v51
    v_max_f32 v10, v10, v30
    v_mov_b32 v52, v10
    s_nop 1
    v_permlane16_swap_b32 v10, v52
    s_nop 1
    v_max_f32 v10, v10, v52
    v_mov_b32 v52, v10
    s_nop 1
    v_permlane32_swap_b32 v10, v52
    s_nop 1
    v_max_f32 v10, v10, v52
    v_sub_f32 v30, v30, v10
    v_sub_f32 v31, v31, v10
    v_sub_f32 v32, v32, v10
    v_sub_f32 v33, v33, v10
    v_sub_f32 v34, v34, v10
    v_sub_f32 v35, v35, v10
    v_sub_f32 v36, v36, v10
    v_sub_f32 v37, v37, v10
    v_sub_f32 v38, v38, v10
    v_sub_f32 v39, v39, v10
    v_sub_f32 v40, v40, v10
    v_sub_f32 v41, v41, v10
    v_sub_f32 v42, v42, v10
    v_sub_f32 v43, v43, v10
    v_sub_f32 v44, v44, v10
    v_sub_f32 v45, v45, v10
    v_sub_f32 v46, v46, v10
    v_sub_f32 v47, v47, v10
    v_sub_f32 v48, v48, v10
    v_sub_f32 v49, v49, v10
    v_sub_f32 v50, v50, v10
    v_sub_f32 v51, v51, v10
    v_exp_f32 v30, v30
    v_mov_b64 v[68:69], 0
    v_exp_f32 v31, v31
    v_mov_b64 v[72:73], 0
    v_exp_f32 v32, v32
    v_mov_b64 v[76:77], 0
    v_exp_f32 v33, v33
    v_mov_b64 v[80:81], 0
    v_exp_f32 v34, v34
    v_mov_b64 v[84:85], 0
    v_exp_f32 v35, v35
    v_mov_b64 v[88:89], 0
    v_exp_f32 v36, v36
    v_mov_b64 v[92:93], 0
    v_exp_f32 v37, v37
    v_mov_b64 v[96:97], 0
    v_exp_f32 v38, v38
    v_mov_b64 v[100:101], 0
    v_exp_f32 v39, v39
    v_mov_b64 v[104:105], 0
    v_exp_f32 v40, v40
    v_mov_b64 v[108:109], 0
    v_exp_f32 v41, v41
    v_mov_b64 v[112:113], 0
    v_exp_f32 v42, v42
    v_mov_b64 v[116:117], 0
    v_exp_f32 v43, v43
    v_mov_b64 v[120:121], 0
    v_exp_f32 v44, v44
    v_mov_b64 v[124:125], 0
    v_exp_f32 v45, v45
    v_mov_b64 v[128:129], 0
    v_exp_f32 v46, v46
    v_mov_b64 v[132:133], 0
    v_exp_f32 v47, v47
    v_mov_b64 v[136:137], 0
    v_exp_f32 v48, v48
    v_mov_b64 v[140:141], 0
    v_exp_f32 v49, v49
    v_mov_b64 v[144:145], 0
    v_exp_f32 v50, v50
    v_mov_b64 v[148:149], 0
    v_exp_f32 v51, v51
    v_mov_b64 v[152:153], 0
    v_mov_b64 v[156:157], 0
    v_pk_add_f32 v[64:65], v[30:31], v[32:33]
    v_pk_add_f32 v[64:65], v[64:65], v[34:35]
    v_pk_add_f32 v[64:65], v[64:65], v[36:37]
    v_pk_add_f32 v[64:65], v[64:65], v[38:39]
    v_pk_add_f32 v[64:65], v[64:65], v[40:41]
    v_pk_add_f32 v[64:65], v[64:65], v[42:43]
    v_pk_add_f32 v[64:65], v[64:65], v[44:45]
    v_pk_add_f32 v[64:65], v[64:65], v[46:47]
    v_pk_add_f32 v[64:65], v[64:65], v[48:49]
    v_pk_add_f32 v[64:65], v[64:65], v[50:51]
    v_add_f32 v11, v64, v65
    v_mov_b32 v64, v11
    s_nop 1
    v_permlane16_swap_b32 v11, v64
    s_nop 1
    v_add_f32 v11, v11, v64
    v_mov_b32 v64, v11
    s_nop 1
    v_permlane32_swap_b32 v11, v64
    s_nop 1
    v_add_f32 v11, v11, v64
    v_lshl_add_u32 v64, v3, 5, s6
    s_mov_b64 exec, 0x1111
    ds_write_b32 v64, v10
    ds_write_b32 v64, v11 offset:128
    s_mov_b64 exec, -1
    v_cvt_pk_bf16_f32 v52, v30, v31
    v_cvt_pk_bf16_f32 v53, v32, v33
    v_cvt_pk_bf16_f32 v54, v34, v35
    v_cvt_pk_bf16_f32 v55, v36, v37
    v_cvt_pk_bf16_f32 v56, v38, v39
    v_cvt_pk_bf16_f32 v57, v40, v41
    v_cvt_pk_bf16_f32 v58, v42, v43
    v_cvt_pk_bf16_f32 v59, v44, v45
    v_cvt_pk_bf16_f32 v60, v46, v47
    v_cvt_pk_bf16_f32 v61, v48, v49
    v_cvt_pk_bf16_f32 v62, v50, v51
    v_perm_b32 v70, v52, v52, v13
    v_perm_b32 v71, v52, v52, v15
    v_perm_b32 v74, v52, v52, v14
    v_perm_b32 v75, v52, v52, v16
    v_perm_b32 v78, v53, v53, v13
    v_perm_b32 v79, v53, v53, v15
    v_perm_b32 v82, v53, v53, v14
    v_perm_b32 v83, v53, v53, v16
    v_perm_b32 v86, v54, v54, v13
    v_perm_b32 v87, v54, v54, v15
    v_perm_b32 v90, v54, v54, v14
    v_perm_b32 v91, v54, v54, v16
    v_perm_b32 v94, v55, v55, v13
    v_perm_b32 v95, v55, v55, v15
    v_perm_b32 v98, v55, v55, v14
    v_perm_b32 v99, v55, v55, v16
    v_perm_b32 v102, v56, v56, v13
    v_perm_b32 v103, v56, v56, v15
    v_perm_b32 v106, v56, v56, v14
    v_perm_b32 v107, v56, v56, v16
    v_perm_b32 v110, v57, v57, v13
    v_perm_b32 v111, v57, v57, v15
    v_perm_b32 v114, v57, v57, v14
    v_perm_b32 v115, v57, v57, v16
    v_perm_b32 v118, v58, v58, v13
    v_perm_b32 v119, v58, v58, v15
    v_perm_b32 v122, v58, v58, v14
    v_perm_b32 v123, v58, v58, v16
    v_perm_b32 v126, v59, v59, v13
    v_perm_b32 v127, v59, v59, v15
    v_perm_b32 v130, v59, v59, v14
    v_perm_b32 v131, v59, v59, v16
    v_perm_b32 v134, v60, v60, v13
    v_perm_b32 v135, v60, v60, v15
    v_perm_b32 v138, v60, v60, v14
    v_perm_b32 v139, v60, v60, v16
    v_perm_b32 v142, v61, v61, v13
    v_perm_b32 v143, v61, v61, v15
    v_perm_b32 v146, v61, v61, v14
    v_perm_b32 v147, v61, v61, v16
    v_perm_b32 v150, v62, v62, v13
    v_perm_b32 v151, v62, v62, v15
    v_perm_b32 v154, v62, v62, v14
    v_perm_b32 v155, v62, v62, v16
    s_waitcnt lgkmcnt(0)
    s_cmp_lt_u32 s36, 4
    s_cbranch_scc1 L_softdone
    s_barrier
    s_branch L_softdone
L_inter:
    s_nop 1
    v_mfma_f32_16x16x32_bf16 v[52:55], v[70:73], v[18:21], 0
    v_mfma_f32_16x16x32_bf16 v[56:59], v[74:77], v[18:21], 0
    v_mfma_f32_16x16x32_bf16 v[60:63], v[78:81], v[18:21], 0
    s_nop 5
    v_mfma_f32_16x16x32_bf16 v[64:67], v[82:85], v[18:21], 0
    v_mul_f32_dpp v30, v52, v9 quad_perm:[0,0,0,0] row_mask:0xf bank_mask:0xf
    v_fmac_f32_dpp v30, v53, v9 quad_perm:[1,1,1,1] row_mask:0xf bank_mask:0xf
    v_fmac_f32_dpp v30, v54, v9 quad_perm:[2,2,2,2] row_mask:0xf bank_mask:0xf
    v_fmac_f32_dpp v30, v55, v9 quad_perm:[3,3,3,3] row_mask:0xf bank_mask:0xf
    v_mfma_f32_16x16x32_bf16 v[52:55], v[86:89], v[18:21], 0
    v_mul_f32_dpp v31, v56, v9 quad_perm:[0,0,0,0] row_mask:0xf bank_mask:0xf
    v_fmac_f32_dpp v31, v57, v9 quad_perm:[1,1,1,1] row_mask:0xf bank_mask:0xf
    v_fmac_f32_dpp v31, v58, v9 quad_perm:[2,2,2,2] row_mask:0xf bank_mask:0xf
    v_fmac_f32_dpp v31, v59, v9 quad_perm:[3,3,3,3] row_mask:0xf bank_mask:0xf
    v_mfma_f32_16x16x32_bf16 v[56:59], v[90:93], v[18:21], 0
    s_add_u32 s41, s40, 8192
    buffer_load_dwordx4 v[194:197], v7, s[12:15], s41 offen offset:0 nt
    v_mul_f32_dpp v32, v60, v9 quad_perm:[0,0,0,0] row_mask:0xf bank_mask:0xf
    v_fmac_f32_dpp v32, v61, v9 quad_perm:[1,1,1,1] row_mask:0xf bank_mask:0xf
    v_fmac_f32_dpp v32, v62, v9 quad_perm:[2,2,2,2] row_mask:0xf bank_mask:0xf
    v_fmac_f32_dpp v32, v63, v9 quad_perm:[3,3,3,3] row_mask:0xf bank_mask:0xf
    v_mfma_f32_16x16x32_bf16 v[60:63], v[94:97], v[18:21], 0
    v_mul_f32_dpp v33, v64, v9 quad_perm:[0,0,0,0] row_mask:0xf bank_mask:0xf
    v_fmac_f32_dpp v33, v65, v9 quad_perm:[1,1,1,1] row_mask:0xf bank_mask:0xf
    v_fmac_f32_dpp v33, v66, v9 quad_perm:[2,2,2,2] row_mask:0xf bank_mask:0xf
    v_fmac_f32_dpp v33, v67, v9 quad_perm:[3,3,3,3] row_mask:0xf bank_mask:0xf
    v_mfma_f32_16x16x32_bf16 v[64:67], v[98:101], v[18:21], 0
    v_mul_f32_dpp v34, v52, v9 quad_perm:[0,0,0,0] row_mask:0xf bank_mask:0xf
    v_fmac_f32_dpp v34, v53, v9 quad_perm:[1,1,1,1] row_mask:0xf bank_mask:0xf
    v_fmac_f32_dpp v34, v54, v9 quad_perm:[2,2,2,2] row_mask:0xf bank_mask:0xf
    v_fmac_f32_dpp v34, v55, v9 quad_perm:[3,3,3,3] row_mask:0xf bank_mask:0xf
    v_mfma_f32_16x16x32_bf16 v[52:55], v[102:105], v[18:21], 0
    v_mul_f32_dpp v35, v56, v9 quad_perm:[0,0,0,0] row_mask:0xf bank_mask:0xf
    v_fmac_f32_dpp v35, v57, v9 quad_perm:[1,1,1,1] row_mask:0xf bank_mask:0xf
    v_fmac_f32_dpp v35, v58, v9 quad_perm:[2,2,2,2] row_mask:0xf bank_mask:0xf
    v_fmac_f32_dpp v35, v59, v9 quad_perm:[3,3,3,3] row_mask:0xf bank_mask:0xf
    v_mfma_f32_16x16x32_bf16 v[56:59], v[106:109], v[18:21], 0
    v_mul_f32_dpp v36, v60, v9 quad_perm:[0,0,0,0] row_mask:0xf bank_mask:0xf
    v_fmac_f32_dpp v36, v61, v9 quad_perm:[1,1,1,1] row_mask:0xf bank_mask:0xf
    v_fmac_f32_dpp v36, v62, v9 quad_perm:[2,2,2,2] row_mask:0xf bank_mask:0xf
    v_fmac_f32_dpp v36, v63, v9 quad_perm:[3,3,3,3] row_mask:0xf bank_mask:0xf
    v_mfma_f32_16x16x32_bf16 v[60:63], v[110:113], v[18:21], 0
    v_mul_f32_dpp v37, v64, v9 quad_perm:[0,0,0,0] row_mask:0xf bank_mask:0xf
    v_fmac_f32_dpp v37, v65, v9 quad_perm:[1,1,1,1] row_mask:0xf bank_mask:0xf
    v_fmac_f32_dpp v37, v66, v9 quad_perm:[2,2,2,2] row_mask:0xf bank_mask:0xf
    v_fmac_f32_dpp v37, v67, v9 quad_perm:[3,3,3,3] row_mask:0xf bank_mask:0xf
    v_mfma_f32_16x16x32_bf16 v[64:67], v[114:117], v[18:21], 0
    v_mul_f32_dpp v38, v52, v9 quad_perm:[0,0,0,0] row_mask:0xf bank_mask:0xf
    v_fmac_f32_dpp v38, v53, v9 quad_perm:[1,1,1,1] row_mask:0xf bank_mask:0xf
    buffer_load_dwordx4 v[198:201], v7, s[12:15], s41 offen offset:1024 nt
    v_fmac_f32_dpp v38, v54, v9 quad_perm:[2,2,2,2] row_mask:0xf bank_mask:0xf
    v_fmac_f32_dpp v38, v55, v9 quad_perm:[3,3,3,3] row_mask:0xf bank_mask:0xf
    v_mfma_f32_16x16x32_bf16 v[52:55], v[118:121], v[18:21], 0
    v_mul_f32_dpp v39, v56, v9 quad_perm:[0,0,0,0] row_mask:0xf bank_mask:0xf
    v_fmac_f32_dpp v39, v57, v9 quad_perm:[1,1,1,1] row_mask:0xf bank_mask:0xf
    v_fmac_f32_dpp v39, v58, v9 quad_perm:[2,2,2,2] row_mask:0xf bank_mask:0xf
    v_fmac_f32_dpp v39, v59, v9 quad_perm:[3,3,3,3] row_mask:0xf bank_mask:0xf
    v_mfma_f32_16x16x32_bf16 v[56:59], v[122:125], v[18:21], 0
    v_mul_f32_dpp v40, v60, v9 quad_perm:[0,0,0,0] row_mask:0xf bank_mask:0xf
    v_fmac_f32_dpp v40, v61, v9 quad_perm:[1,1,1,1] row_mask:0xf bank_mask:0xf
    v_fmac_f32_dpp v40, v62, v9 quad_perm:[2,2,2,2] row_mask:0xf bank_mask:0xf
    v_fmac_f32_dpp v40, v63, v9 quad_perm:[3,3,3,3] row_mask:0xf bank_mask:0xf
    v_mfma_f32_16x16x32_bf16 v[60:63], v[126:129], v[18:21], 0
    v_mul_f32_dpp v41, v64, v9 quad_perm:[0,0,0,0] row_mask:0xf bank_mask:0xf
    v_fmac_f32_dpp v41, v65, v9 quad_perm:[1,1,1,1] row_mask:0xf bank_mask:0xf
    v_fmac_f32_dpp v41, v66, v9 quad_perm:[2,2,2,2] row_mask:0xf bank_mask:0xf
    v_fmac_f32_dpp v41, v67, v9 quad_perm:[3,3,3,3] row_mask:0xf bank_mask:0xf
    v_mfma_f32_16x16x32_bf16 v[64:67], v[130:133], v[18:21], 0
    v_mul_f32_dpp v42, v52, v9 quad_perm:[0,0,0,0] row_mask:0xf bank_mask:0xf
    v_fmac_f32_dpp v42, v53, v9 quad_perm:[1,1,1,1] row_mask:0xf bank_mask:0xf
    v_fmac_f32_dpp v42, v54, v9 quad_perm:[2,2,2,2] row_mask:0xf bank_mask:0xf
    v_fmac_f32_dpp v42, v55, v9 quad_perm:[3,3,3,3] row_mask:0xf bank_mask:0xf
    v_mfma_f32_16x16x32_bf16 v[52:55], v[134:137], v[18:21], 0
    v_mul_f32_dpp v43, v56, v9 quad_perm:[0,0,0,0] row_mask:0xf bank_mask:0xf
    v_fmac_f32_dpp v43, v57, v9 quad_perm:[1,1,1,1] row_mask:0xf bank_mask:0xf
    v_fmac_f32_dpp v43, v58, v9 quad_perm:[2,2,2,2] row_mask:0xf bank_mask:0xf
    v_fmac_f32_dpp v43, v59, v9 quad_perm:[3,3,3,3] row_mask:0xf bank_mask:0xf
    v_mfma_f32_16x16x32_bf16 v[56:59], v[138:141], v[18:21], 0
    v_mul_f32_dpp v44, v60, v9 quad_perm:[0,0,0,0] row_mask:0xf bank_mask:0xf
    v_fmac_f32_dpp v44, v61, v9 quad_perm:[1,1,1,1] row_mask:0xf bank_mask:0xf
    v_fmac_f32_dpp v44, v62, v9 quad_perm:[2,2,2,2] row_mask:0xf bank_mask:0xf
    v_fmac_f32_dpp v44, v63, v9 quad_perm:[3,3,3,3] row_mask:0xf bank_mask:0xf
    v_mfma_f32_16x16x32_bf16 v[60:63], v[142:145], v[18:21], 0
    buffer_load_dwordx4 v[202:205], v7, s[12:15], s41 offen offset:2048 nt
    v_mul_f32_dpp v45, v64, v9 quad_perm:[0,0,0,0] row_mask:0xf bank_mask:0xf
    v_fmac_f32_dpp v45, v65, v9 quad_perm:[1,1,1,1] row_mask:0xf bank_mask:0xf
    v_fmac_f32_dpp v45, v66, v9 quad_perm:[2,2,2,2] row_mask:0xf bank_mask:0xf
    v_fmac_f32_dpp v45, v67, v9 quad_perm:[3,3,3,3] row_mask:0xf bank_mask:0xf
    v_mfma_f32_16x16x32_bf16 v[64:67], v[146:149], v[18:21], 0
    v_mul_f32_dpp v46, v52, v9 quad_perm:[0,0,0,0] row_mask:0xf bank_mask:0xf
    v_fmac_f32_dpp v46, v53, v9 quad_perm:[1,1,1,1] row_mask:0xf bank_mask:0xf
    v_fmac_f32_dpp v46, v54, v9 quad_perm:[2,2,2,2] row_mask:0xf bank_mask:0xf
    v_fmac_f32_dpp v46, v55, v9 quad_perm:[3,3,3,3] row_mask:0xf bank_mask:0xf
    v_mfma_f32_16x16x32_bf16 v[52:55], v[150:153], v[18:21], 0
    v_mul_f32_dpp v47, v56, v9 quad_perm:[0,0,0,0] row_mask:0xf bank_mask:0xf
    v_fmac_f32_dpp v47, v57, v9 quad_perm:[1,1,1,1] row_mask:0xf bank_mask:0xf
    v_fmac_f32_dpp v47, v58, v9 quad_perm:[2,2,2,2] row_mask:0xf bank_mask:0xf
    v_fmac_f32_dpp v47, v59, v9 quad_perm:[3,3,3,3] row_mask:0xf bank_mask:0xf
    v_mfma_f32_16x16x32_bf16 v[56:59], v[154:157], v[18:21], 0
    v_mul_f32_dpp v48, v60, v9 quad_perm:[0,0,0,0] row_mask:0xf bank_mask:0xf
    v_fmac_f32_dpp v48, v61, v9 quad_perm:[1,1,1,1] row_mask:0xf bank_mask:0xf
    v_fmac_f32_dpp v48, v62, v9 quad_perm:[2,2,2,2] row_mask:0xf bank_mask:0xf
    v_fmac_f32_dpp v48, v63, v9 quad_perm:[3,3,3,3] row_mask:0xf bank_mask:0xf
    s_nop 0
    v_mul_f32_dpp v49, v64, v9 quad_perm:[0,0,0,0] row_mask:0xf bank_mask:0xf
    v_fmac_f32_dpp v49, v65, v9 quad_perm:[1,1,1,1] row_mask:0xf bank_mask:0xf
    v_fmac_f32_dpp v49, v66, v9 quad_perm:[2,2,2,2] row_mask:0xf bank_mask:0xf
    v_fmac_f32_dpp v49, v67, v9 quad_perm:[3,3,3,3] row_mask:0xf bank_mask:0xf
    s_nop 0
    v_mul_f32_dpp v50, v52, v9 quad_perm:[0,0,0,0] row_mask:0xf bank_mask:0xf
    v_fmac_f32_dpp v50, v53, v9 quad_perm:[1,1,1,1] row_mask:0xf bank_mask:0xf
    v_fmac_f32_dpp v50, v54, v9 quad_perm:[2,2,2,2] row_mask:0xf bank_mask:0xf
    v_fmac_f32_dpp v50, v55, v9 quad_perm:[3,3,3,3] row_mask:0xf bank_mask:0xf
    s_nop 0
    v_mul_f32_dpp v51, v56, v9 quad_perm:[0,0,0,0] row_mask:0xf bank_mask:0xf
    v_fmac_f32_dpp v51, v57, v9 quad_perm:[1,1,1,1] row_mask:0xf bank_mask:0xf
    buffer_load_dwordx4 v[206:209], v7, s[12:15], s41 offen offset:3072 nt
    v_fmac_f32_dpp v51, v58, v9 quad_perm:[2,2,2,2] row_mask:0xf bank_mask:0xf
    v_fmac_f32_dpp v51, v59, v9 quad_perm:[3,3,3,3] row_mask:0xf bank_mask:0xf
    v_add_f32 v30, s3, v30
    v_max3_f32 v10, v31, v32, v33
    v_max3_f32 v10, v10, v34, v35
    v_max3_f32 v10, v10, v36, v37
    v_max3_f32 v10, v10, v38, v39
    v_max3_f32 v10, v10, v40, v41
    v_max3_f32 v10, v10, v42, v43
    v_max3_f32 v10, v10, v44, v45
    v_max3_f32 v10, v10, v46, v47
    v_max3_f32 v10, v10, v48, v49
    v_max3_f32 v10, v10, v50, v51
    v_max_f32 v10, v10, v30
    v_mov_b32 v52, v10
    s_nop 1
    v_permlane16_swap_b32 v10, v52
    s_nop 1
    v_max_f32 v10, v10, v52
    v_mov_b32 v52, v10
    s_nop 1
    v_permlane32_swap_b32 v10, v52
    s_nop 1
    v_max_f32 v10, v10, v52
    v_sub_f32 v30, v30, v10
    v_sub_f32 v31, v31, v10
    v_sub_f32 v32, v32, v10
    v_sub_f32 v33, v33, v10
    v_sub_f32 v34, v34, v10
    v_sub_f32 v35, v35, v10
    v_sub_f32 v36, v36, v10
    v_sub_f32 v37, v37, v10
    s_add_u32 s41, s40, 12288
    buffer_load_dwordx4 v[210:213], v7, s[12:15], s41 offen offset:0 nt
    v_sub_f32 v38, v38, v10
    v_sub_f32 v39, v39, v10
    v_sub_f32 v40, v40, v10
    v_sub_f32 v41, v41, v10
    v_sub_f32 v42, v42, v10
    v_sub_f32 v43, v43, v10
    v_sub_f32 v44, v44, v10
    v_sub_f32 v45, v45, v10
    v_sub_f32 v46, v46, v10
    v_sub_f32 v47, v47, v10
    v_sub_f32 v48, v48, v10
    v_sub_f32 v49, v49, v10
    v_sub_f32 v50, v50, v10
    v_sub_f32 v51, v51, v10
    v_exp_f32 v30, v30
    v_mov_b64 v[68:69], 0
    v_exp_f32 v31, v31
    v_mov_b64 v[72:73], 0
    v_exp_f32 v32, v32
    v_mov_b64 v[76:77], 0
    v_exp_f32 v33, v33
    v_mov_b64 v[80:81], 0
    v_exp_f32 v34, v34
    v_mov_b64 v[84:85], 0
    v_exp_f32 v35, v35
    v_mov_b64 v[88:89], 0
    v_exp_f32 v36, v36
    v_mov_b64 v[92:93], 0
    v_exp_f32 v37, v37
    v_mov_b64 v[96:97], 0
    v_exp_f32 v38, v38
    v_mov_b64 v[100:101], 0
    v_exp_f32 v39, v39
    buffer_load_dwordx4 v[214:217], v7, s[12:15], s41 offen offset:1024 nt
    v_mov_b64 v[104:105], 0
    v_exp_f32 v40, v40
    v_mov_b64 v[108:109], 0
    v_exp_f32 v41, v41
    v_mov_b64 v[112:113], 0
    v_exp_f32 v42, v42
    v_mov_b64 v[116:117], 0
    v_exp_f32 v43, v43
    v_mov_b64 v[120:121], 0
    v_exp_f32 v44, v44
    v_mov_b64 v[124:125], 0
    v_exp_f32 v45, v45
    v_mov_b64 v[128:129], 0
    v_exp_f32 v46, v46
    v_mov_b64 v[132:133], 0
    v_exp_f32 v47, v47
    v_mov_b64 v[136:137], 0
    v_exp_f32 v48, v48
    v_mov_b64 v[140:141], 0
    v_exp_f32 v49, v49
    v_mov_b64 v[144:145], 0
    v_exp_f32 v50, v50
    v_mov_b64 v[148:149], 0
    v_exp_f32 v51, v51
    v_mov_b64 v[152:153], 0
    v_mov_b64 v[156:157], 0
    v_pk_add_f32 v[64:65], v[30:31], v[32:33]
    v_pk_add_f32 v[64:65], v[64:65], v[34:35]
    v_pk_add_f32 v[64:65], v[64:65], v[36:37]
    v_pk_add_f32 v[64:65], v[64:65], v[38:39]
    v_pk_add_f32 v[64:65], v[64:65], v[40:41]
    v_pk_add_f32 v[64:65], v[64:65], v[42:43]
    buffer_load_dwordx4 v[218:221], v7, s[12:15], s41 offen offset:2048 nt
    v_pk_add_f32 v[64:65], v[64:65], v[44:45]
    v_pk_add_f32 v[64:65], v[64:65], v[46:47]
    v_pk_add_f32 v[64:65], v[64:65], v[48:49]
    v_pk_add_f32 v[64:65], v[64:65], v[50:51]
    v_add_f32 v11, v64, v65
    v_mov_b32 v64, v11
    s_nop 1
    v_permlane16_swap_b32 v11, v64
    s_nop 1
    v_add_f32 v11, v11, v64
    v_mov_b32 v64, v11
    s_nop 1
    v_permlane32_swap_b32 v11, v64
    s_nop 1
    v_add_f32 v11, v11, v64
    v_lshl_add_u32 v64, v3, 5, s6
    s_mov_b64 exec, 0x1111
    ds_write_b32 v64, v10
    ds_write_b32 v64, v11 offset:128
    s_mov_b64 exec, -1
    s_waitcnt lgkmcnt(0)
    s_barrier
    v_cvt_pk_bf16_f32 v52, v30, v31
    v_cvt_pk_bf16_f32 v53, v32, v33
    v_cvt_pk_bf16_f32 v54, v34, v35
    v_cvt_pk_bf16_f32 v55, v36, v37
    v_cvt_pk_bf16_f32 v56, v38, v39
    v_cvt_pk_bf16_f32 v57, v40, v41
    v_cvt_pk_bf16_f32 v58, v42, v43
    v_cvt_pk_bf16_f32 v59, v44, v45
    v_cvt_pk_bf16_f32 v60, v46, v47
    v_cvt_pk_bf16_f32 v61, v48, v49
    v_cvt_pk_bf16_f32 v62, v50, v51
    v_perm_b32 v70, v52, v52, v13
    v_perm_b32 v71, v52, v52, v15
    v_perm_b32 v74, v52, v52, v14
    v_perm_b32 v75, v52, v52, v16
    v_perm_b32 v78, v53, v53, v13
    v_perm_b32 v79, v53, v53, v15
    v_perm_b32 v82, v53, v53, v14
    v_perm_b32 v83, v53, v53, v16
    v_perm_b32 v86, v54, v54, v13
    v_perm_b32 v87, v54, v54, v15
    v_perm_b32 v90, v54, v54, v14
    v_perm_b32 v91, v54, v54, v16
    v_perm_b32 v94, v55, v55, v13
    v_perm_b32 v95, v55, v55, v15
    v_perm_b32 v98, v55, v55, v14
    v_perm_b32 v99, v55, v55, v16
    v_perm_b32 v102, v56, v56, v13
    v_perm_b32 v103, v56, v56, v15
    v_perm_b32 v106, v56, v56, v14
    v_perm_b32 v107, v56, v56, v16
    v_perm_b32 v110, v57, v57, v13
    v_perm_b32 v111, v57, v57, v15
    v_perm_b32 v114, v57, v57, v14
    v_perm_b32 v115, v57, v57, v16
    v_perm_b32 v118, v58, v58, v13
    buffer_load_dwordx4 v[222:225], v7, s[12:15], s41 offen offset:3072 nt
    v_perm_b32 v119, v58, v58, v15
    v_perm_b32 v122, v58, v58, v14
    v_perm_b32 v123, v58, v58, v16
    s_add_u32 s41, s40, 16384
    buffer_load_dwordx4 v[226:229], v7, s[12:15], s41 offen offset:0 nt
    v_perm_b32 v126, v59, v59, v13
    v_perm_b32 v127, v59, v59, v15
    v_perm_b32 v130, v59, v59, v14
    buffer_load_dwordx4 v[230:233], v7, s[12:15], s41 offen offset:1024 nt
    v_perm_b32 v131, v59, v59, v16
    v_perm_b32 v134, v60, v60, v13
    v_perm_b32 v135, v60, v60, v15
    buffer_load_dwordx4 v[234:237], v7, s[12:15], s41 offen offset:2048 nt
    v_perm_b32 v138, v60, v60, v14
    v_perm_b32 v139, v60, v60, v16
    v_perm_b32 v142, v61, v61, v13
    buffer_load_dwordx4 v[238:241], v7, s[12:15], s41 offen offset:3072 nt
    v_perm_b32 v143, v61, v61, v15
    v_perm_b32 v146, v61, v61, v14
    v_perm_b32 v147, v61, v61, v16
    s_add_u32 s41, s40, 20480
    buffer_load_dwordx4 v[242:245], v7, s[12:15], s41 offen offset:0 nt
    v_perm_b32 v150, v62, v62, v13
    v_perm_b32 v151, v62, v62, v15
    v_perm_b32 v154, v62, v62, v14
    v_perm_b32 v155, v62, v62, v16
L_softdone:
    v_mov_b64 v[22:23], 0
    v_mov_b64 v[24:25], 0
    v_mov_b64 v[26:27], 0
    v_mov_b64 v[28:29], 0
    v_add_u32 v8, s7, v7
    s_cmp_lt_u32 s36, 4
    s_cbranch_scc1 L_pv
    v_lshlrev_b32 v64, 5, v2
    v_add_u32 v65, s6, v64
    ds_read_b128 v[52:55], v64 offset:0
    ds_read_b128 v[56:59], v64 offset:16
    ds_read_b32 v12, v65
    s_waitcnt lgkmcnt(0)
    v_max3_f32 v10, v52, v53, v54
    v_max3_f32 v10, v10, v55, v56
    v_max3_f32 v10, v10, v57, v58
    v_max_f32 v10, v10, v59
    v_sub_f32 v12, v12, v10
    v_exp_f32 v12, v12
L_pv:
    s_waitcnt vmcnt(21)
    v_mfma_f32_16x16x32_bf16 v[22:25], v[70:73], v[158:161], v[22:25]
    v_mfma_f32_16x16x32_bf16 v[26:29], v[68:71], v[158:161], v[26:29]
    s_waitcnt vmcnt(20)
    v_mfma_f32_16x16x32_bf16 v[22:25], v[74:77], v[162:165], v[22:25]
    v_mfma_f32_16x16x32_bf16 v[26:29], v[72:75], v[162:165], v[26:29]
    s_waitcnt vmcnt(19)
    v_mfma_f32_16x16x32_bf16 v[22:25], v[78:81], v[166:169], v[22:25]
    v_mfma_f32_16x16x32_bf16 v[26:29], v[76:79], v[166:169], v[26:29]
    s_waitcnt vmcnt(18)
    v_mfma_f32_16x16x32_bf16 v[22:25], v[82:85], v[170:173], v[22:25]
    v_mfma_f32_16x16x32_bf16 v[26:29], v[80:83], v[170:173], v[26:29]
    s_waitcnt vmcnt(17)
    v_mfma_f32_16x16x32_bf16 v[22:25], v[86:89], v[174:177], v[22:25]
    v_mfma_f32_16x16x32_bf16 v[26:29], v[84:87], v[174:177], v[26:29]
    s_waitcnt vmcnt(16)
    v_mfma_f32_16x16x32_bf16 v[22:25], v[90:93], v[178:181], v[22:25]
    v_mfma_f32_16x16x32_bf16 v[26:29], v[88:91], v[178:181], v[26:29]
    s_waitcnt vmcnt(15)
    v_mfma_f32_16x16x32_bf16 v[22:25], v[94:97], v[182:185], v[22:25]
    v_mfma_f32_16x16x32_bf16 v[26:29], v[92:95], v[182:185], v[26:29]
    s_waitcnt vmcnt(14)
    v_mfma_f32_16x16x32_bf16 v[22:25], v[98:101], v[186:189], v[22:25]
    v_mfma_f32_16x16x32_bf16 v[26:29], v[96:99], v[186:189], v[26:29]
    s_waitcnt vmcnt(13)
    v_mfma_f32_16x16x32_bf16 v[22:25], v[102:105], v[190:193], v[22:25]
    v_mfma_f32_16x16x32_bf16 v[26:29], v[100:103], v[190:193], v[26:29]
    s_waitcnt vmcnt(12)
    v_mfma_f32_16x16x32_bf16 v[22:25], v[106:109], v[194:197], v[22:25]
    v_mfma_f32_16x16x32_bf16 v[26:29], v[104:107], v[194:197], v[26:29]
    s_waitcnt vmcnt(11)
    v_mfma_f32_16x16x32_bf16 v[22:25], v[110:113], v[198:201], v[22:25]
    v_mfma_f32_16x16x32_bf16 v[26:29], v[108:111], v[198:201], v[26:29]
    s_waitcnt vmcnt(10)
    v_mfma_f32_16x16x32_bf16 v[22:25], v[114:117], v[202:205], v[22:25]
    v_mfma_f32_16x16x32_bf16 v[26:29], v[112:115], v[202:205], v[26:29]
    s_waitcnt vmcnt(9)
    v_mfma_f32_16x16x32_bf16 v[22:25], v[118:121], v[206:209], v[22:25]
    v_mfma_f32_16x16x32_bf16 v[26:29], v[116:119], v[206:209], v[26:29]
    s_waitcnt vmcnt(8)
    v_mfma_f32_16x16x32_bf16 v[22:25], v[122:125], v[210:213], v[22:25]
    v_mfma_f32_16x16x32_bf16 v[26:29], v[120:123], v[210:213], v[26:29]
    s_waitcnt vmcnt(7)
    v_mfma_f32_16x16x32_bf16 v[22:25], v[126:129], v[214:217], v[22:25]
    v_mfma_f32_16x16x32_bf16 v[26:29], v[124:127], v[214:217], v[26:29]
    s_waitcnt vmcnt(6)
    v_mfma_f32_16x16x32_bf16 v[22:25], v[130:133], v[218:221], v[22:25]
    v_mfma_f32_16x16x32_bf16 v[26:29], v[128:131], v[218:221], v[26:29]
    s_waitcnt vmcnt(5)
    v_mfma_f32_16x16x32_bf16 v[22:25], v[134:137], v[222:225], v[22:25]
    v_mfma_f32_16x16x32_bf16 v[26:29], v[132:135], v[222:225], v[26:29]
    s_waitcnt vmcnt(4)
    v_mfma_f32_16x16x32_bf16 v[22:25], v[138:141], v[226:229], v[22:25]
    v_mfma_f32_16x16x32_bf16 v[26:29], v[136:139], v[226:229], v[26:29]
    s_waitcnt vmcnt(3)
    v_mfma_f32_16x16x32_bf16 v[22:25], v[142:145], v[230:233], v[22:25]
    v_mfma_f32_16x16x32_bf16 v[26:29], v[140:143], v[230:233], v[26:29]
    s_waitcnt vmcnt(2)
    v_mfma_f32_16x16x32_bf16 v[22:25], v[146:149], v[234:237], v[22:25]
    v_mfma_f32_16x16x32_bf16 v[26:29], v[144:147], v[234:237], v[26:29]
    s_waitcnt vmcnt(1)
    v_mfma_f32_16x16x32_bf16 v[22:25], v[150:153], v[238:241], v[22:25]
    v_mfma_f32_16x16x32_bf16 v[26:29], v[148:151], v[238:241], v[26:29]
    s_waitcnt vmcnt(0)
    v_mfma_f32_16x16x32_bf16 v[22:25], v[154:157], v[242:245], v[22:25]
    v_mfma_f32_16x16x32_bf16 v[26:29], v[152:155], v[242:245], v[26:29]
    s_cmp_ge_u32 s36, 4
    s_cbranch_scc1 L_owrite
    v_and_b32 v6, 7, v1
    v_lshlrev_b32 v6, 2, v6
    s_branch L_rdychk
L_rdy:
    s_sleep 8
    buffer_load_dword v17, v6, s[16:19], s46 offen sc1
L_rdychk:
    s_waitcnt vmcnt(0)
    v_subrev_u32 v17, s39, v17
    v_cmp_lt_u32 vcc, 1, v17
    s_add_u32 s43, s43, 1
    s_cmp_gt_u32 s43, 400000
    s_cbranch_scc1 L_rdyok
    s_cbranch_vccnz L_rdy
L_rdyok:
    v_readfirstlane_b32 s45, v17
    v_lshrrev_b32 v6, 2, v0
    v_lshlrev_b32 v6, 4, v6
    v_and_b32 v54, 1, v0
    v_lshl_add_u32 v6, v54, 3, v6
    v_bfe_u32 v54, v0, 1, 1
    v_mul_u32_u24 v54, 1152, v54
    v_add_u32 v6, v6, v54
    v_lshrrev_b32 v9, 5, v0
    v_lshlrev_b32 v9, 12, v9
    v_bfe_u32 v54, v0, 4, 1
    v_lshl_add_u32 v9, v54, 10, v9
    v_lshl_add_u32 v9, v5, 2, v9
    s_mov_b32 s46, s44
    v_lshlrev_b32 v60, 8, v2
    s_lshl_b32 s42, s37, 10
    s_lshl_b32 s41, s38, 3
    s_add_u32 s42, s42, s41
    s_add_u32 s42, s42, 131072
    s_barrier
    v_lshlrev_b32 v64, 5, v2
    v_add_u32 v65, s6, v64
    ds_read_b128 v[52:55], v64 offset:0
    ds_read_b128 v[56:59], v64 offset:16
    ds_read_b32 v12, v65
    ds_read_b128 v[30:33], v64 offset:128
    ds_read_b128 v[34:37], v64 offset:144
    s_waitcnt lgkmcnt(0)
    v_max3_f32 v10, v52, v53, v54
    v_max3_f32 v10, v10, v55, v56
    v_max3_f32 v10, v10, v57, v58
    v_max_f32 v10, v10, v59
    v_sub_f32 v12, v12, v10
    v_exp_f32 v12, v12
    s_cmp_lg_u32 s36, 0
    s_cbranch_scc1 L_owrite
    v_sub_f32 v52, v52, v10
    v_sub_f32 v53, v53, v10
    v_sub_f32 v54, v54, v10
    v_sub_f32 v55, v55, v10
    v_sub_f32 v56, v56, v10
    v_sub_f32 v57, v57, v10
    v_sub_f32 v58, v58, v10
    v_sub_f32 v59, v59, v10
    v_exp_f32 v52, v52
    v_exp_f32 v53, v53
    v_exp_f32 v54, v54
    v_exp_f32 v55, v55
    v_exp_f32 v56, v56
    v_exp_f32 v57, v57
    v_exp_f32 v58, v58
    v_exp_f32 v59, v59
    v_mul_f32 v11, v52, v30
    v_fmac_f32 v11, v53, v31
    v_fmac_f32 v11, v54, v32
    v_fmac_f32 v11, v55, v33
    v_fmac_f32 v11, v56, v34
    v_fmac_f32 v11, v57, v35
    v_fmac_f32 v11, v58, v36
    v_fmac_f32 v11, v59, v37
    s_mov_b32 exec_lo, 0x00010001
    s_mov_b32 exec_hi, 0x00010001
    s_cmp_lg_u32 s45, 0
    s_cbranch_scc1 L_t1
    buffer_store_dwordx2 v[10:11], v60, s[16:19], s42 offen
    s_branch L_t2
L_t1:
    buffer_store_dwordx2 v[10:11], v60, s[16:19], s42 offen sc1
L_t2:
    s_mov_b64 exec, -1
L_owrite:
    s_nop 4
    v_mul_f32 v22, v22, v12
    v_mul_f32 v23, v23, v12
    v_mul_f32 v24, v24, v12
    v_mul_f32 v25, v25, v12
    v_mul_f32 v26, v26, v12
    v_mul_f32 v27, v27, v12
    v_mul_f32 v28, v28, v12
    v_mul_f32 v29, v29, v12
    ds_write_b128 v8, v[22:25]
    ds_write_b128 v8, v[26:29] offset:1152
    s_waitcnt lgkmcnt(0)
    s_barrier
    s_cmp_ge_u32 s36, 4
    s_cbranch_scc1 L_red
    ds_read_b64 v[30:31], v6 offset:256
    ds_read_b64 v[32:33], v6 offset:2560
    ds_read_b64 v[34:35], v6 offset:4864
    ds_read_b64 v[36:37], v6 offset:7168
    ds_read_b64 v[38:39], v6 offset:9472
    ds_read_b64 v[40:41], v6 offset:11776
    ds_read_b64 v[42:43], v6 offset:14080
    ds_read_b64 v[44:45], v6 offset:16384
    s_waitcnt lgkmcnt(6)
    v_pk_add_f32 v[30:31], v[30:31], v[32:33]
    s_waitcnt lgkmcnt(4)
    v_pk_add_f32 v[34:35], v[34:35], v[36:37]
    s_waitcnt lgkmcnt(2)
    v_pk_add_f32 v[38:39], v[38:39], v[40:41]
    v_pk_add_f32 v[30:31], v[30:31], v[34:35]
    s_waitcnt lgkmcnt(0)
    v_pk_add_f32 v[42:43], v[42:43], v[44:45]
    v_pk_add_f32 v[30:31], v[30:31], v[38:39]
    v_pk_add_f32 v[30:31], v[30:31], v[42:43]
    v_cvt_pk_bf16_f32 v30, v30, v31
    s_cmp_lg_u32 s45, 0
    s_cbranch_scc1 L_t3
    buffer_store_dword v30, v9, s[16:19], s46 offen
    s_branch L_t4
L_t3:
    buffer_store_dword v30, v9, s[16:19], s46 offen sc1
L_t4:
    s_branch L_fin
L_red:
    s_cmp_ge_u32 s38, 16
    s_cbranch_scc1 L_fin
    s_cmp_lg_u32 s36, 4
    s_cbranch_scc1 L_fin
    s_mov_b32 s6, s39
    s_mov_b32 s7, s39
    s_lshl_b32 s44, s37, 4
    s_add_u32 s44, s44, s38
    s_lshl_b32 s47, s44, 7
    s_add_u32 s47, s47, 16384
    s_mov_b32 s32, s66
    s_mov_b32 s33, s67
    s_mov_b32 s34, 0x1000
    s_mov_b32 s35, 0x20000
    s_mov_b32 s28, s48
    s_mov_b32 s29, s49
    s_mov_b32 s30, 0x1000
    s_mov_b32 s31, 0x20000
    v_lshrrev_b32 v52, 2, v1
    v_lshlrev_b32 v52, 13, v52
    v_lshl_add_u32 v52, v4, 4, v52
    v_lshrrev_b32 v54, 5, v1
    v_bfe_u32 v55, v1, 4, 1
    v_lshl_add_u32 v54, v55, 1, v54
    v_lshl_add_u32 v54, v4, 2, v54
    v_lshlrev_b32 v54, 1, v54
    s_lshl_b32 s46, s44, 5
    buffer_load_ushort v56, v54, s[28:31], s46 offen
    s_lshl_b32 s40, s44, 6
    s_bfe_u32 s41, s6, 0x80000
    v_mov_b32 v60, s41
    v_mov_b32 v64, s41
    s_bfe_u32 s41, s6, 0x80008
    v_mov_b32 v61, s41
    v_mov_b32 v65, s41
    s_bfe_u32 s41, s6, 0x80010
    v_mov_b32 v62, s41
    v_mov_b32 v66, s41
    s_bfe_u32 s41, s6, 0x80018
    v_mov_b32 v63, s41
    v_mov_b32 v67, s41
    s_mul_i32 s41, s44, 4032
    s_add_u32 s41, s41, 1051648
    v_add_u32 v53, s41, v7
    s_mov_b32 exec_lo, 0
    v_mov_b32 v64, 0
    v_mov_b32 v65, 0
    v_mov_b32 v66, 0
    v_mov_b32 v67, 0
    v_add_u32 v53, 458752, v52
    s_mov_b32 exec_lo, -1
    s_mov_b32 s43, 0
    s_lshl_b32 s42, s44, 12
    s_add_u32 s42, s42, 1048576
    s_add_u32 s41, s42, 1024
    s_add_u32 s3, s42, 2048
    v_mov_b32 v52, v7
    s_not_b32 s48, s39
L_rh2:
    s_load_dwordx8 s[48:55], s[16:17], s47 offset:32 glc
    s_add_u32 s43, s43, 1
    s_cmp_gt_u32 s43, 3200000
    s_cbranch_scc1 L_rh2ok
    s_waitcnt lgkmcnt(4)
    s_xor_b64 s[56:57], s[48:49], s[6:7]
    s_xor_b64 s[58:59], s[50:51], s[6:7]
    s_xor_b64 s[60:61], s[52:53], s[6:7]
    s_xor_b64 s[62:63], s[54:55], s[6:7]
    s_or_b64 s[56:57], s[56:57], s[58:59]
    s_or_b64 s[60:61], s[60:61], s[62:63]
    s_or_b64 s[56:57], s[56:57], s[60:61]
    s_cbranch_scc1 L_rh2
L_rh2ok:
    s_sleep 8
    s_mov_b64 vcc, -1
    s_mov_b32 s43, 0
L_dpoll:
    s_mov_b64 exec, vcc
    buffer_load_dwordx4 v[158:161], v52, s[16:19], s42 offen sc1
    buffer_load_dwordx4 v[162:165], v52, s[16:19], s41 offen sc1
    buffer_load_dwordx4 v[166:169], v52, s[16:19], s3 offen sc1
    buffer_load_dwordx4 v[170:173], v53, s[16:19], s40 offen sc1
    s_mov_b64 exec, -1
    s_waitcnt vmcnt(3)
    v_xor_b32 v174, v158, v60
    v_xor_b32 v175, v159, v61
    v_xor_b32 v176, v160, v62
    v_xor_b32 v177, v161, v63
    s_waitcnt vmcnt(2)
    v_xor_b32 v178, v162, v60
    v_xor_b32 v179, v163, v61
    v_xor_b32 v180, v164, v62
    v_xor_b32 v181, v165, v63
    s_waitcnt vmcnt(1)
    v_xor_b32 v182, v166, v60
    v_xor_b32 v183, v167, v61
    v_xor_b32 v184, v168, v62
    v_xor_b32 v185, v169, v63
    s_waitcnt vmcnt(0)
    v_xor_b32 v186, v170, v64
    v_xor_b32 v187, v171, v65
    v_xor_b32 v188, v172, v66
    v_xor_b32 v189, v173, v67
    v_or3_b32 v59, v174, v175, v176
    v_or3_b32 v59, v59, v177, v178
    v_or3_b32 v59, v59, v179, v180
    v_or3_b32 v59, v59, v181, v182
    v_or3_b32 v59, v59, v183, v184
    v_or_b32 v59, v59, v185
    s_mov_b32 exec_hi, 0
    v_or3_b32 v59, v59, v186, v187
    v_or3_b32 v59, v59, v188, v189
    s_mov_b32 exec_hi, -1
    v_max3_u32 v58, v170, v171, v172
    v_max_u32 v58, v58, v173
    v_and_b32 v59, 0xff, v59
    v_cmp_ne_u32 vcc, 0, v59
    v_cmp_eq_u32 s[4:5], -1, v58
    s_or_b32 vcc_hi, vcc_hi, s5
    s_mov_b64 vcc, vcc
    v_pk_add_f32 v[174:175], v[174:175], v[178:179]
    v_pk_add_f32 v[176:177], v[176:177], v[180:181]
    v_pk_add_f32 v[182:183], v[182:183], v[186:187]
    v_pk_add_f32 v[184:185], v[184:185], v[188:189]
    s_add_u32 s43, s43, 1
    s_cmp_gt_u32 s43, 400000
    s_cbranch_scc1 L_dok
    s_cbranch_vccnz L_dpoll
L_dok:
    v_pk_add_f32 v[174:175], v[174:175], v[182:183]
    v_pk_add_f32 v[176:177], v[176:177], v[184:185]
    v_lshlrev_b32 v59, 16, v56
    s_nop 0
    v_permlane32_swap_b32 v174, v175
    v_permlane32_swap_b32 v176, v177
    s_nop 1
    v_add_f32 v174, v174, v175
    v_add_f32 v176, v176, v177
    s_nop 1
    v_permlane16_swap_b32 v174, v176
    s_nop 1
    v_add_f32 v174, v174, v176
    s_nop 1
    v_add_f32_dpp v174, v174, v174 row_ror:8 row_mask:0xf bank_mask:0xf
    s_nop 1
    v_add_f32_dpp v174, v174, v174 row_ror:4 row_mask:0xf bank_mask:0xf
    v_add_f32 v174, v174, v59
    v_cvt_pk_bf16_f32 v174, v174, v174
    s_mov_b32 exec_lo, 0x000f000f
    s_mov_b32 exec_hi, 0x000f000f
    buffer_store_short v174, v54, s[32:35], s46 offen
    s_cmp_lg_u32 s44, 0
    s_cbranch_scc1 L_fin
    s_mov_b64 exec, 1
    v_mov_b32 v175, s39
    buffer_store_dword v175, v7, s[16:19], 0 offen
L_fin:
L_end:
    s_endpgm
L_service:
    s_mov_b32 s16, s70
    s_mov_b32 s17, s71
    v_lshl_add_u32 v230, v12, 10, v13
    v_lshl_add_u32 v231, v12, 10, v14
    s_mov_b32 s28, s48
    s_mov_b32 s29, s49
    s_mov_b32 s30, 0x1000
    s_mov_b32 s31, 0x20000
    s_mov_b32 s24, s56
    s_mov_b32 s25, s57
    s_mov_b32 s26, 0x400000
    s_mov_b32 s27, 0x20000
    v_mov_b32 v36, 0x3f803f80
    v_mov_b32 v37, 0x3f803f80
    v_mov_b32 v38, 0x3f803f80
    v_mov_b32 v39, 0x3f803f80
    v_mov_b32 v40, 0x3f803f80
    v_mov_b32 v41, 0x3f803f80
    v_mov_b32 v42, 0x3f803f80
    v_mov_b32 v43, 0x3f803f80
    v_lshlrev_b32 v19, 10, v4
    v_lshl_add_u32 v19, v2, 4, v19
    s_lshl_b32 s41, s36, 7
    s_mov_b32 exec_lo, 0x000f000f
    s_mov_b32 exec_hi, 0x000f000f
    buffer_load_dwordx4 v[36:39], v19, s[28:31], s41 offen
    buffer_load_dwordx4 v[40:43], v19, s[28:31], s41 offen offset:64
    s_mov_b64 exec, -1
    s_getreg_b32 s7, hwreg(HW_REG_XCC_ID, 0, 4)
    v_lshlrev_b32 v20, 4, v1
    s_mul_i32 s44, s37, 7
    s_add_u32 s44, s44, s38
    s_cmp_gt_u32 s38, 3
    s_subb_u32 s44, s44, 0
    s_waitcnt lgkmcnt(0)
    s_add_u32 s39, s39, 0x1010101
    v_mov_b32 v168, -1
    v_mov_b32 v169, -1
    v_mov_b32 v170, -1
    v_mov_b32 v171, -1
    v_mov_b32 v228, s39
    v_mov_b32 v172, s39
    v_mov_b32 v173, s7
    s_cmp_lg_u32 s36, 0
    s_cbranch_scc1 L_noxc
    s_lshl_b32 s42, s37, 5
    s_add_u32 s42, s42, s38
    s_lshl_b32 s42, s42, 3
    s_add_u32 s42, s42, 8192
    s_mov_b64 exec, 1
    buffer_store_dwordx2 v[172:173], v20, s[16:19], s42 offen sc1
    s_mov_b64 exec, -1
L_noxc:
    s_cmp_lt_u32 s36, 4
    s_cbranch_scc1 L_noapc
    s_and_b32 s42, s36, 3
    s_lshl_b32 s42, s42, 11
    s_lshl_b32 s41, s37, 13
    s_add_u32 s42, s42, s41
    s_lshl_b32 s41, s38, 8
    s_add_u32 s42, s42, s41
    s_add_u32 s42, s42, 524288
    s_mov_b64 exec, 0xffff
    buffer_store_dwordx4 v[168:171], v20, s[16:19], s42 offen sc1
    s_mov_b64 exec, -1
L_noapc:
    v_lshlrev_b32 v242, 11, v2
    v_lshl_add_u32 v242, v5, 4, v242
    v_lshlrev_b32 v241, 17, v4
    v_lshl_add_u32 v241, v3, 12, v241
    v_lshl_add_u32 v241, v2, 4, v241
    v_lshrrev_b32 v21, 1, v3
    v_and_b32 v22, 1, v2
    v_lshl_or_b32 v21, v22, 1, v21
    v_lshlrev_b32 v22, 10, v2
    v_lshl_add_u32 v22, v3, 7, v22
    v_lshl_add_u32 v22, v4, 3, v22
    v_add_u32 v22, s40, v22
    v_xor_b32 v23, 0, v21
    v_lshl_add_u32 v7, v23, 5, v22
    v_xor_b32 v23, 1, v21
    v_lshl_add_u32 v8, v23, 5, v22
    v_xor_b32 v23, 2, v21
    v_lshl_add_u32 v9, v23, 5, v22
    v_xor_b32 v23, 3, v21
    v_lshl_add_u32 v10, v23, 5, v22
    v_mul_u32_u24 v229, 10240, v2
    v_lshl_add_u32 v229, v5, 4, v229
    s_lshl_b32 s41, s36, 8
    s_add_u32 s41, s41, 9728
    v_add_u32 v229, s41, v229
    s_lshl_b32 s6, s37, 19
    s_lshl_b32 s41, s36, 16
    s_add_u32 s6, s6, s41
    s_lshl_b32 s41, s38, 7
    s_add_u32 s6, s6, s41
    v_and_b32 v21, 31, v1
    v_lshlrev_b32 v21, 3, v21
    s_lshl_b32 s42, s37, 8
    s_add_u32 s42, s42, 8192
    s_mov_b32 s43, 0
    s_cmp_lg_u32 s36, 7
    s_cbranch_scc1 L_noxl
    buffer_load_dwordx2 v[22:23], v21, s[16:19], s42 offen sc1
L_noxl:
    s_barrier
    s_cmp_lg_u32 s38, 3
    s_cbranch_scc1 L_wo1
    s_waitcnt vmcnt(0)
    s_branch L_wo1d
L_wo1:
    s_mov_b32 m0, s46
    s_add_u32 s46, s46, 1024
    buffer_load_dwordx4 v230, s[24:27], s6 offen nt lds
    s_add_u32 s6, s6, 8192
    s_mov_b32 m0, s46
    s_add_u32 s46, s46, 1024
    buffer_load_dwordx4 v231, s[24:27], s6 offen nt lds
    s_add_u32 s6, s6, 8192
    s_mov_b32 m0, s46
    s_add_u32 s46, s46, 1024
    buffer_load_dwordx4 v230, s[24:27], s6 offen nt lds
    s_add_u32 s6, s6, 8192
    s_mov_b32 m0, s46
    s_add_u32 s46, s46, 1024
    buffer_load_dwordx4 v231, s[24:27], s6 offen nt lds
    s_add_u32 s6, s6, 8192
    s_waitcnt vmcnt(4)
L_wo1d:
    s_cmp_lg_u32 s36, 7
    s_cbranch_scc1 L_qgo
    s_branch L_xchk
L_xpoll:
    buffer_load_dwordx2 v[22:23], v21, s[16:19], s42 offen sc1
    s_waitcnt vmcnt(0)
L_xchk:
    v_cmp_ne_u32 vcc, s39, v22
    s_add_u32 s43, s43, 1
    s_cmp_gt_u32 s43, 400000
    s_cbranch_scc1 L_xok
    s_cbranch_vccnz L_xpoll
L_xok:
    v_cmp_ne_u32 s[4:5], s7, v23
    s_or_b64 vcc, vcc, s[4:5]
    s_cmp_lg_u64 vcc, 0
    s_cselect_b32 s45, 1, 0
    v_mov_b32 v21, s45
    v_mov_b32 v22, 0
    ds_write_b32 v22, v21 offset:7616
    ds_write_b32 v22, v22 offset:7620
L_qgo:
    ds_read_b64_tr_b16 v[120:121], v7 offset:0
    ds_read_b64_tr_b16 v[122:123], v7 offset:512
    ds_read_b64_tr_b16 v[124:125], v8 offset:0
    ds_read_b64_tr_b16 v[126:127], v8 offset:512
    ds_read_b64_tr_b16 v[128:129], v9 offset:0
    ds_read_b64_tr_b16 v[130:131], v9 offset:512
    ds_read_b64_tr_b16 v[132:133], v10 offset:0
    ds_read_b64_tr_b16 v[134:135], v10 offset:512
    ds_read_b64_tr_b16 v[136:137], v7 offset:4096
    ds_read_b64_tr_b16 v[138:139], v7 offset:4608
    ds_read_b64_tr_b16 v[140:141], v8 offset:4096
    ds_read_b64_tr_b16 v[142:143], v8 offset:4608
    ds_read_b64_tr_b16 v[144:145], v9 offset:4096
    ds_read_b64_tr_b16 v[146:147], v9 offset:4608
    ds_read_b64_tr_b16 v[148:149], v10 offset:4096
    ds_read_b64_tr_b16 v[150:151], v10 offset:4608
    v_mfma_f32_16x16x32_bf16 v[68:71], v[36:39], v[36:39], 0
    v_mfma_f32_16x16x32_bf16 v[68:71], v[40:43], v[40:43], v[68:71]
    s_waitcnt lgkmcnt(8)
    v_mfma_f32_16x16x32_bf16 v[52:55], v[36:39], v[120:123], 0
    v_mfma_f32_16x16x32_bf16 v[56:59], v[36:39], v[124:127], 0
    v_mfma_f32_16x16x32_bf16 v[60:63], v[36:39], v[128:131], 0
    v_mfma_f32_16x16x32_bf16 v[64:67], v[36:39], v[132:135], 0
    s_waitcnt lgkmcnt(0)
    v_mfma_f32_16x16x32_bf16 v[52:55], v[40:43], v[136:139], v[52:55]
    v_mfma_f32_16x16x32_bf16 v[56:59], v[40:43], v[140:143], v[56:59]
    v_mfma_f32_16x16x32_bf16 v[60:63], v[40:43], v[144:147], v[60:63]
    v_mfma_f32_16x16x32_bf16 v[64:67], v[40:43], v[148:151], v[64:67]
    s_nop 3
    s_mov_b32 exec_hi, 0
    ds_write_b128 v229, v[68:71] offset:8192
    ds_write_b128 v229, v[52:55] offset:0
    ds_write_b128 v229, v[56:59] offset:2048
    ds_write_b128 v229, v[60:63] offset:4096
    ds_write_b128 v229, v[64:67] offset:6144
    s_mov_b32 exec_hi, -1
    s_waitcnt lgkmcnt(0)
    s_barrier
    s_cmp_ge_u32 s36, 4
    s_cbranch_scc1 L_qdone
    s_lshl_b32 s41, s36, 11
    s_add_u32 s41, s41, 9728
    v_lshl_add_u32 v13, v1, 2, s41
    v_mul_u32_u24 v14, 20, v4
    v_add_u32 v14, 17920, v14
    v_lshlrev_b32 v19, 2, v4
    v_add_u32 v19, 17984, v19
    v_mov_b32 v22, 0
    ds_read_b32 v21, v22 offset:7616
    ds_read2st64_b32 v[184:185], v13 offset0:0 offset1:1
    ds_read2st64_b32 v[186:187], v13 offset0:2 offset1:3
    ds_read2st64_b32 v[188:189], v13 offset0:4 offset1:5
    ds_read2st64_b32 v[190:191], v13 offset0:6 offset1:7
    ds_read2st64_b32 v[192:193], v13 offset0:40 offset1:41
    ds_read2st64_b32 v[194:195], v13 offset0:42 offset1:43
    ds_read2st64_b32 v[196:197], v13 offset0:44 offset1:45
    ds_read2st64_b32 v[198:199], v13 offset0:46 offset1:47
    ds_read2st64_b32 v[200:201], v19 offset0:0 offset1:1
    ds_read2st64_b32 v[202:203], v19 offset0:2 offset1:3
    ds_read2st64_b32 v[204:205], v19 offset0:4 offset1:5
    ds_read2st64_b32 v[206:207], v19 offset0:6 offset1:7
    ds_read2st64_b32 v[208:209], v14 offset0:0 offset1:1
    ds_read2st64_b32 v[210:211], v14 offset0:2 offset1:3
    ds_read2st64_b32 v[212:213], v14 offset0:4 offset1:5
    ds_read2st64_b32 v[214:215], v14 offset0:6 offset1:7
    v_lshrrev_b32 v12, 5, v1
    v_lshlrev_b32 v12, 4, v12
    v_bfe_u32 v13, v1, 4, 1
    v_lshl_add_u32 v12, v13, 10, v12
    v_bfe_u32 v13, v1, 3, 1
    v_lshl_add_u32 v12, v13, 3, v12
    v_lshl_add_u32 v12, v4, 14, v12
    s_waitcnt lgkmcnt(0)
    v_readfirstlane_b32 s45, v21
    v_pk_add_f32 v[184:185], v[184:185], v[186:187]
    v_pk_add_f32 v[188:189], v[188:189], v[190:191]
    v_pk_add_f32 v[192:193], v[192:193], v[194:195]
    v_pk_add_f32 v[196:197], v[196:197], v[198:199]
    v_pk_add_f32 v[200:201], v[200:201], v[202:203]
    v_pk_add_f32 v[204:205], v[204:205], v[206:207]
    v_pk_add_f32 v[208:209], v[208:209], v[210:211]
    v_pk_add_f32 v[212:213], v[212:213], v[214:215]
    v_pk_add_f32 v[184:185], v[184:185], v[188:189]
    v_pk_add_f32 v[192:193], v[192:193], v[196:197]
    v_pk_add_f32 v[200:201], v[200:201], v[204:205]
    v_pk_add_f32 v[208:209], v[208:209], v[212:213]
    v_add_f32 v184, v184, v185
    v_add_f32 v192, v192, v193
    v_add_f32 v200, v200, v201
    v_add_f32 v208, v208, v209
    v_mul_f32 v200, 0x3b000000, v200
    v_mul_f32 v208, 0x3b000000, v208
    v_fma_f32 v208, -v200, v200, v208
    v_max_f32 v208, 0, v208
    v_add_f32 v208, 0x3727c5ac, v208
    v_rsq_f32 v208, v208
    v_fma_f32 v184, -v200, v192, v184
    v_mul_f32 v184, v184, v208
    s_lshl_b32 s42, s36, 5
    s_lshl_b32 s41, s37, 11
    v_mov_b32_dpp v185, v184 row_shl:4 row_mask:0xf bank_mask:0xf
    s_add_u32 s42, s42, s41
    s_lshl_b32 s41, s38, 7
    s_add_u32 s42, s42, s41
    s_add_u32 s42, s42, 65536
    v_cvt_pk_bf16_f32 v184, v184, v185
    v_mov_b32 v185, s39
    s_mov_b32 exec_lo, 0x0f0f0f0f
    s_mov_b32 exec_hi, 0x0f0f0f0f
    s_cmp_lg_u32 s45, 0
    s_cbranch_scc1 L_t5
    buffer_store_dwordx2 v[184:185], v12, s[16:19], s42 offen
    s_branch L_t6
L_t5:
    buffer_store_dwordx2 v[184:185], v12, s[16:19], s42 offen sc1
L_t6:
    s_mov_b64 exec, -1
L_qdone:
    s_barrier
    s_cmp_lg_u32 s38, 3
    s_cbranch_scc1 L_wo2
    v_mov_b32 v22, 0
    ds_read_b32 v21, v22 offset:7616
    s_lshl_b32 s41, s37, 3
    s_add_u32 s41, s41, s36
    s_lshl_b32 s42, s41, 12
    s_add_u32 s42, s42, 262144
    s_lshl_b32 s41, s41, 7
    s_add_u32 s41, s41, 131072
    s_waitcnt lgkmcnt(0)
    v_readfirstlane_b32 s45, v21
    s_mov_b32 exec_lo, 0x00ffffff
    s_mov_b32 exec_hi, 0x00ffffff
    s_cmp_lg_u32 s45, 0
    s_cbranch_scc1 L_t7
    buffer_store_dwordx4 v[168:171], v20, s[16:19], s42 offen offset:0
    s_branch L_t8
L_t7:
    buffer_store_dwordx4 v[168:171], v20, s[16:19], s42 offen offset:0 sc1
L_t8:
    s_cmp_lg_u32 s45, 0
    s_cbranch_scc1 L_t9
    buffer_store_dwordx4 v[168:171], v20, s[16:19], s42 offen offset:1024
    s_branch L_t10
L_t9:
    buffer_store_dwordx4 v[168:171], v20, s[16:19], s42 offen offset:1024 sc1
L_t10:
    s_cmp_lg_u32 s45, 0
    s_cbranch_scc1 L_t11
    buffer_store_dwordx4 v[168:171], v20, s[16:19], s42 offen offset:2048
    s_branch L_t12
L_t11:
    buffer_store_dwordx4 v[168:171], v20, s[16:19], s42 offen offset:2048 sc1
L_t12:
    s_cmp_lg_u32 s45, 0
    s_cbranch_scc1 L_t13
    buffer_store_dwordx4 v[168:171], v20, s[16:19], s42 offen offset:3072
    s_branch L_t14
L_t13:
    buffer_store_dwordx4 v[168:171], v20, s[16:19], s42 offen offset:3072 sc1
L_t14:
    s_mov_b64 exec, 0xff
    s_cmp_lg_u32 s45, 0
    s_cbranch_scc1 L_t15
    buffer_store_dwordx4 v[168:171], v20, s[16:19], s41 offen
    s_branch L_t16
L_t15:
    buffer_store_dwordx4 v[168:171], v20, s[16:19], s41 offen sc1
L_t16:
    s_mov_b64 exec, 1
    s_lshl_b32 s42, s37, 5
    s_add_u32 s42, s42, s36
    s_lshl_b32 s42, s42, 2
    s_add_u32 s42, s42, 4096
    s_add_u32 s41, s39, s45
    v_mov_b32 v186, s41
    s_waitcnt vmcnt(0)
    s_cmp_lg_u32 s45, 0
    s_cbranch_scc1 L_t17
    buffer_store_dword v186, v20, s[16:19], s42 offen
    s_branch L_t18
L_t17:
    buffer_store_dword v186, v20, s[16:19], s42 offen sc1
L_t18:
    s_mov_b64 exec, -1
    s_mov_b32 m0, s46
    s_add_u32 s46, s46, 1024
    buffer_load_dwordx4 v230, s[24:27], s6 offen nt lds
    s_add_u32 s6, s6, 8192
    s_mov_b32 m0, s46
    s_add_u32 s46, s46, 1024
    buffer_load_dwordx4 v231, s[24:27], s6 offen nt lds
    s_add_u32 s6, s6, 8192
    s_mov_b32 m0, s46
    s_add_u32 s46, s46, 1024
    buffer_load_dwordx4 v230, s[24:27], s6 offen nt lds
    s_add_u32 s6, s6, 8192
    s_mov_b32 m0, s46
    s_add_u32 s46, s46, 1024
    buffer_load_dwordx4 v231, s[24:27], s6 offen nt lds
    s_add_u32 s6, s6, 8192
L_wo2:
    s_mov_b32 m0, s46
    s_add_u32 s46, s46, 1024
    buffer_load_dwordx4 v230, s[24:27], s6 offen nt lds
    s_add_u32 s6, s6, 8192
    s_mov_b32 m0, s46
    s_add_u32 s46, s46, 1024
    buffer_load_dwordx4 v231, s[24:27], s6 offen nt lds
    s_add_u32 s6, s6, 8192
    s_mov_b32 m0, s46
    s_add_u32 s46, s46, 1024
    buffer_load_dwordx4 v230, s[24:27], s6 offen nt lds
    s_add_u32 s6, s6, 8192
    s_mov_b32 m0, s46
    s_add_u32 s46, s46, 1024
    buffer_load_dwordx4 v231, s[24:27], s6 offen nt lds
    s_add_u32 s6, s6, 8192
    s_cmp_eq_u32 s38, 3
    s_cbranch_scc1 L_nogu
    s_mov_b32 s20, s60
    s_mov_b32 s21, s61
    s_mov_b32 s22, 0x1c0000
    s_mov_b32 s23, 0x20000
    s_mov_b32 s24, s62
    s_mov_b32 s25, s63
    s_mov_b32 s26, 0x1c0000
    s_mov_b32 s27, 0x20000
    v_lshrrev_b32 v12, 2, v1
    v_mul_u32_u24 v12, 3584, v12
    v_lshl_add_u32 v12, v4, 4, v12
    s_lshl_b32 s42, s44, 6
    s_mul_i32 s41, s36, 229376
    s_add_u32 s42, s42, s41
    s_mov_b32 s46, s40
    s_mov_b32 m0, s46
    s_add_u32 s46, s46, 4096
    buffer_load_dwordx4 v12, s[20:23], s42 offen nt lds
    s_mov_b32 m0, s46
    s_sub_u32 s46, s46, 3072
    buffer_load_dwordx4 v12, s[24:27], s42 offen nt lds
    s_add_u32 s42, s42, 57344
    s_mov_b32 m0, s46
    s_add_u32 s46, s46, 4096
    buffer_load_dwordx4 v12, s[20:23], s42 offen nt lds
    s_mov_b32 m0, s46
    s_sub_u32 s46, s46, 3072
    buffer_load_dwordx4 v12, s[24:27], s42 offen nt lds
    s_add_u32 s42, s42, 57344
    s_mov_b32 m0, s46
    s_add_u32 s46, s46, 4096
    buffer_load_dwordx4 v12, s[20:23], s42 offen nt lds
    s_mov_b32 m0, s46
    s_sub_u32 s46, s46, 3072
    buffer_load_dwordx4 v12, s[24:27], s42 offen nt lds
    s_add_u32 s42, s42, 57344
    s_mov_b32 m0, s46
    s_add_u32 s46, s46, 4096
    buffer_load_dwordx4 v12, s[20:23], s42 offen nt lds
    s_mov_b32 m0, s46
    s_sub_u32 s46, s46, 3072
    buffer_load_dwordx4 v12, s[24:27], s42 offen nt lds
    s_add_u32 s42, s42, 57344
    s_mov_b32 s20, s64
    s_mov_b32 s21, s65
    s_mov_b32 s22, 0x1c0000
    s_mov_b32 s23, 0x20000
    s_lshl_b32 s42, s44, 15
    s_lshl_b32 s41, s36, 7
    s_add_u32 s42, s42, s41
    buffer_load_dwordx4 v[168:171], v230, s[20:23], s42 offen nt
    s_add_u32 s42, s42, 8192
    buffer_load_dwordx4 v[172:175], v231, s[20:23], s42 offen nt
    s_add_u32 s42, s42, 8192
    buffer_load_dwordx4 v[176:179], v230, s[20:23], s42 offen nt
    s_add_u32 s42, s42, 8192
    buffer_load_dwordx4 v[180:183], v231, s[20:23], s42 offen nt
    s_add_u32 s42, s42, 8192
    v_lshlrev_b32 v12, 10, v2
    v_lshl_add_u32 v12, v5, 3, v12
    s_lshl_b32 s42, s36, 7
    buffer_load_dwordx2 v[216:217], v12, s[28:31], s42 offen
L_nogu:
    v_and_b32 v13, 7, v1
    v_lshlrev_b32 v13, 2, v13
    s_lshl_b32 s42, s37, 7
    s_add_u32 s42, s42, 4096
    buffer_load_dword v243, v13, s[16:19], s42 offen sc1
    s_setprio 0
    v_lshlrev_b32 v11, 9, v2
    v_lshl_add_u32 v11, v3, 6, v11
    v_lshl_add_u32 v11, v4, 3, v11
    v_add_u32 v11, s40, v11
    s_mul_i32 s41, s36, 768
    s_add_u32 s41, s41, 1024
    v_mul_u32_u24 v234, 144, v2
    v_lshl_add_u32 v234, v5, 3, v234
    v_add_u32 v234, s41, v234
    v_mul_u32_u24 v17, 144, v4
    v_lshl_add_u32 v17, v2, 4, v17
    v_add_u32 v17, s41, v17
    s_add_u32 s42, s41, 576
    v_mov_b32 v18, s42
    v_mov_b32 v23, 0
    v_mov_b32 v24, 0
    v_mov_b32 v36, 0x3f803f80
    v_mov_b32 v37, 0x3f803f80
    v_mov_b32 v38, 0x3f803f80
    v_mov_b32 v39, 0x3f803f80
    v_lshl_add_u32 v14, v5, 3, s41
    ds_write2_b32 v14, v23, v24 offset0:144 offset1:145
    s_and_b32 s41, s36, 1
    s_lshl_b32 s42, s41, 6
    s_add_u32 s46, s42, 30208
    v_lshlrev_b32 v237, 8, v2
    v_lshl_add_u32 v237, v5, 2, v237
    v_add_u32 v237, s46, v237
    v_add_u32 v235, 128, v237
    s_add_u32 s42, s42, 7680
    v_lshl_add_u32 v21, v2, 2, v4
    v_lshl_add_u32 v236, v21, 2, s42
    v_lshlrev_b32 v239, 6, v3
    v_lshlrev_b32 v238, 6, v2
    s_lshl_b32 s42, s36, 3
    v_add_u32 v238, s42, v238
    v_mul_u32_u24 v240, 80, v3
    v_lshl_add_u32 v240, v21, 1, v240
    s_lshl_b32 s42, s41, 5
    v_add_u32 v240, s42, v240
    s_lshl_b32 s42, s36, 10
    v_add_u32 v229, s42, v20
    v_mov_b32 v12, 0
    v_lshlrev_b32 v14, 2, v5
    ds_write_b32 v14, v12 offset:7488
    s_lshl_b32 s42, s36, 8
    v_add_u32 v14, s42, v14
    v_add_u32 v16, s40, v20
    v_mul_u32_u24 v21, 80, v4
    v_lshl_add_u32 v21, v2, 4, v21
    v_mov_b32 v22, 320
    v_cmp_eq_u32 vcc, 0, v3
    s_nop 1
    v_cndmask_b32 v224, v22, v21, vcc
    v_cndmask_b32 v248, v18, v17, vcc
    v_cmp_eq_u32 vcc, 1, v3
    s_nop 1
    v_cndmask_b32 v225, v22, v21, vcc
    v_cndmask_b32 v249, v18, v17, vcc
    v_cmp_eq_u32 vcc, 2, v3
    s_nop 1
    v_cndmask_b32 v226, v22, v21, vcc
    v_cndmask_b32 v250, v18, v17, vcc
    v_cmp_eq_u32 vcc, 3, v3
    s_nop 1
    v_cndmask_b32 v227, v22, v21, vcc
    v_cndmask_b32 v251, v18, v17, vcc
    s_cmp_lg_u32 s38, 3
    s_cbranch_scc1 L_wo_w
    s_waitcnt vmcnt(1)
L_wo_w:
    s_waitcnt vmcnt(14)
    ds_read_b64_tr_b16 v[88:89], v7 offset:8192
    ds_read_b64_tr_b16 v[90:91], v7 offset:8704
    ds_read_b64_tr_b16 v[92:93], v8 offset:8192
    ds_read_b64_tr_b16 v[94:95], v8 offset:8704
    ds_read_b64_tr_b16 v[96:97], v9 offset:8192
    ds_read_b64_tr_b16 v[98:99], v9 offset:8704
    ds_read_b64_tr_b16 v[100:101], v10 offset:8192
    ds_read_b64_tr_b16 v[102:103], v10 offset:8704
    ds_read_b64_tr_b16 v[104:105], v7 offset:12288
    ds_read_b64_tr_b16 v[106:107], v7 offset:12800
    ds_read_b64_tr_b16 v[108:109], v8 offset:12288
    ds_read_b64_tr_b16 v[110:111], v8 offset:12800
    ds_read_b64_tr_b16 v[112:113], v9 offset:12288
    ds_read_b64_tr_b16 v[114:115], v9 offset:12800
    ds_read_b64_tr_b16 v[116:117], v10 offset:12288
    ds_read_b64_tr_b16 v[118:119], v10 offset:12800
    s_cmp_eq_u32 s38, 3
    s_cbranch_scc1 L_wdone
    s_waitcnt vmcnt(6)
    ds_read_b64_tr_b16 v[120:121], v11 offset:0
    ds_read_b64_tr_b16 v[122:123], v11 offset:256
    ds_read_b64_tr_b16 v[124:125], v11 offset:32
    ds_read_b64_tr_b16 v[126:127], v11 offset:288
    ds_read_b64_tr_b16 v[128:129], v11 offset:4096
    ds_read_b64_tr_b16 v[130:131], v11 offset:4352
    ds_read_b64_tr_b16 v[132:133], v11 offset:4128
    ds_read_b64_tr_b16 v[134:135], v11 offset:4384
    ds_read_b64_tr_b16 v[136:137], v11 offset:2048
    ds_read_b64_tr_b16 v[138:139], v11 offset:2304
    ds_read_b64_tr_b16 v[140:141], v11 offset:2080
    ds_read_b64_tr_b16 v[142:143], v11 offset:2336
    ds_read_b64_tr_b16 v[144:145], v11 offset:6144
    ds_read_b64_tr_b16 v[146:147], v11 offset:6400
    ds_read_b64_tr_b16 v[148:149], v11 offset:6176
    ds_read_b64_tr_b16 v[150:151], v11 offset:6432
    s_waitcnt lgkmcnt(0)
    v_mfma_f32_16x16x32_bf16 v[52:55], v[36:39], v[120:123], 0
    v_mfma_f32_16x16x32_bf16 v[56:59], v[36:39], v[124:127], 0
    v_mfma_f32_16x16x32_bf16 v[60:63], v[36:39], v[128:131], 0
    v_mfma_f32_16x16x32_bf16 v[64:67], v[36:39], v[132:135], 0
    v_mfma_f32_16x16x32_bf16 v[52:55], v[36:39], v[136:139], v[52:55]
    v_mfma_f32_16x16x32_bf16 v[56:59], v[36:39], v[140:143], v[56:59]
    v_mfma_f32_16x16x32_bf16 v[60:63], v[36:39], v[144:147], v[60:63]
    v_mfma_f32_16x16x32_bf16 v[64:67], v[36:39], v[148:151], v[64:67]
    s_waitcnt vmcnt(1)
    ds_write_b128 v16, v[168:171] offset:8192
    ds_write_b128 v16, v[172:175] offset:9216
    ds_write_b128 v16, v[176:179] offset:10240
    ds_write_b128 v16, v[180:183] offset:11264
    ds_read_b64_tr_b16 v[152:153], v7 offset:8192
    ds_read_b64_tr_b16 v[154:155], v7 offset:8704
    ds_read_b64_tr_b16 v[156:157], v8 offset:8192
    ds_read_b64_tr_b16 v[158:159], v8 offset:8704
    ds_read_b64_tr_b16 v[160:161], v9 offset:8192
    ds_read_b64_tr_b16 v[162:163], v9 offset:8704
    ds_read_b64_tr_b16 v[164:165], v10 offset:8192
    ds_read_b64_tr_b16 v[166:167], v10 offset:8704
    s_mov_b64 exec, 0xffff
    ds_write_b32 v14, v52 offset:7680
    ds_write_b32 v14, v56 offset:7744
    ds_write_b32 v14, v60 offset:7808
    ds_write_b32 v14, v64 offset:7872
    s_mov_b64 exec, -1
    v_lshlrev_b32 v220, 16, v216
    v_and_b32 v221, 0xffff0000, v216
    v_lshlrev_b32 v222, 16, v217
    v_and_b32 v223, 0xffff0000, v217
    s_bfe_u32 s41, s39, 0x80000
    v_mov_b32 v216, s41
    s_bfe_u32 s41, s39, 0x80008
    v_mov_b32 v217, s41
    s_bfe_u32 s41, s39, 0x80010
    v_mov_b32 v218, s41
    s_bfe_u32 s41, s39, 0x80018
    v_mov_b32 v219, s41
L_wdone:
    s_waitcnt lgkmcnt(0)
    v_and_b32 v12, 7, v1
    v_cmp_gt_u32 s[4:5], 6, v12
    v_lshlrev_b32 v13, 2, v12
    v_mov_b32 v26, 0
    s_lshl_b32 s60, s44, 7
    s_add_u32 s60, s60, 655360
    s_lshl_b32 s42, s37, 7
    s_add_u32 s42, s42, 4096
    s_mov_b32 s43, 0
    s_branch L_rchk
L_rpoll:
    buffer_load_dword v243, v13, s[16:19], s42 offen sc1
L_rchk:
    s_waitcnt vmcnt(0)
    v_subrev_u32 v14, s39, v243
    v_cmp_lt_u32 vcc, 1, v14
    s_add_u32 s43, s43, 1
    s_cmp_gt_u32 s43, 400000
    s_cbranch_scc1 L_rdone
    s_cbranch_vccnz L_rpoll
L_rdone:
    v_bfe_u32 v13, v1, 3, 2
    v_mad_u32_u24 v14, v13, 6, v12
    v_lshlrev_b32 v14, 3, v14
    v_lshlrev_b32 v15, 6, v5
    v_lshl_add_u32 v15, v2, 4, v15
    v_lshrrev_b32 v20, 1, v2
    v_lshl_add_u32 v20, v20, 6, v5
    v_mul_u32_u24 v20, 80, v20
    v_and_b32 v21, 1, v2
    v_lshl_add_u32 v20, v21, 2, v20
    s_lshl_b32 s41, s36, 3
    s_add_u32 s41, s41, 9728
    v_add_u32 v20, s41, v20
    v_mul_u32_u24 v21, 80, v0
    v_lshlrev_b32 v22, 2, v1
    s_lshl_b32 s41, s36, 7
    v_lshl_add_u32 v24, v2, 4, s41
    v_add_u32 v25, s41, v22
    s_lshl_b32 s58, s37, 3
    s_add_u32 s58, s58, s36
    s_lshl_b32 s58, s58, 12
    s_add_u32 s58, s58, 262144
    s_lshl_b32 s59, s37, 10
    s_lshr_b32 s41, s36, 1
    s_lshl_b32 s41, s41, 8
    s_add_u32 s59, s59, s41
    s_add_u32 s59, s59, 131072
    s_lshl_b32 s61, s36, 8
    s_add_u32 s61, s61, 524288
    s_mov_b32 s6, 0x3f3f3f3f
    s_mov_b64 s[48:49], s[4:5]
    s_mov_b64 s[50:51], s[4:5]
    s_mov_b32 s57, 0
    s_cmp_eq_u32 s38, 3
    s_cselect_b64 s[52:53], -1, 0
    s_cselect_b64 s[54:55], -1, 0
    s_mov_b32 s3, 0
    s_mov_b32 s43, 0
    v_mov_b32 v16, 0xff800000
    v_mov_b32 v17, 0
    v_cndmask_b32 v36, 0, -1, s[4:5]
    v_cndmask_b32 v37, 0, -1, s[4:5]
    v_cndmask_b32 v38, 0, -1, s[4:5]
    v_cndmask_b32 v39, 0, -1, s[4:5]
    v_cndmask_b32 v40, 0, -1, s[4:5]
    v_cndmask_b32 v41, 0, -1, s[4:5]
    v_cndmask_b32 v42, 0, -1, s[4:5]
    v_cndmask_b32 v43, 0, -1, s[4:5]
    v_cndmask_b32 v44, 0, -1, s[4:5]
    v_cndmask_b32 v45, 0, -1, s[4:5]
    v_cndmask_b32 v46, 0, -1, s[4:5]
    v_cndmask_b32 v47, 0, -1, s[4:5]
    v_cndmask_b32 v48, 0, -1, s[4:5]
    v_cndmask_b32 v49, 0, -1, s[4:5]
    v_cndmask_b32 v50, 0, -1, s[4:5]
    v_cndmask_b32 v51, 0, -1, s[4:5]
    v_mov_b32 v168, -1
    v_mov_b32 v172, -1
    v_mov_b32 v176, -1
    v_mov_b32 v180, -1
    v_mov_b32 v184, -1
    v_mov_b32 v188, -1
    v_mov_b32 v192, -1
    v_mov_b32 v196, -1
    s_add_u32 s20, s61, 0
    s_not_b32 s64, s39
    s_add_u32 s21, s61, 8192
    s_not_b32 s65, s39
    s_add_u32 s22, s61, 16384
    s_not_b32 s66, s39
    s_add_u32 s23, s61, 24576
    s_not_b32 s67, s39
    s_add_u32 s24, s61, 32768
    s_not_b32 s68, s39
    s_add_u32 s25, s61, 40960
    s_not_b32 s69, s39
    s_add_u32 s26, s61, 49152
    s_not_b32 s70, s39
    s_add_u32 s27, s61, 57344
    s_not_b32 s71, s39
    s_mov_b32 s56, 0
    s_lshl_b32 s42, s37, 13
    s_lshl_b32 s41, s36, 11
    s_add_u32 s42, s42, s41
    s_lshl_b32 s41, s38, 8
    s_add_u32 s42, s42, s41
    s_add_u32 s42, s42, 524288
    s_lshl_b32 s7, s37, 2
    s_add_u32 s62, s7, 16384
    s_add_u32 s7, s7, 655360
    s_add_u32 s63, s62, 8192
    s_mul_i32 s41, s38, 896
    s_add_u32 s7, s7, s41
    s_mul_i32 s41, s37, 7
    s_sub_u32 s41, s44, s41
    s_mul_i32 s41, s41, 2432
    s_add_u32 s62, s62, s41
    v_lshlrev_b32 v244, 7, v1
    s_lshl_b32 s10, s38, 3
    s_add_u32 s10, s10, s36
L_ev:
    s_and_b64 exec, s[48:49], s[52:53]
    s_cbranch_execz L_e1
    buffer_load_dwordx4 v[36:39], v15, s[16:19], s58 offen offset:0 sc1
    buffer_load_dwordx4 v[40:43], v15, s[16:19], s58 offen offset:1024 sc1
L_e1:
    s_and_b64 exec, s[50:51], s[54:55]
    s_cbranch_execz L_e2
    buffer_load_dwordx4 v[44:47], v15, s[16:19], s58 offen offset:2048 sc1
    buffer_load_dwordx4 v[48:51], v15, s[16:19], s58 offen offset:3072 sc1
L_e2:
    s_cmp_eq_u32 s6, 0
    s_cbranch_scc1 L_e3
    s_mov_b32 exec_lo, s6
    s_mov_b32 exec_hi, 0
    buffer_load_dwordx2 v[16:17], v14, s[16:19], s59 offen sc1
L_e3:
    s_mov_b64 exec, -1
    s_cmp_lt_u32 s6, 0x10000
    s_cselect_b32 s41, 2, 0
    s_and_b32 s46, s6, 0xffff
    s_cselect_b32 s46, 0, 1
    s_or_b32 s41, s41, s46
    s_cmp_eq_u32 s41, s56
    s_cbranch_scc1 L_e4
    s_mov_b32 s56, s41
    v_mov_b32 v18, v16
    s_nop 1
    v_max_f32_dpp v18, v18, v18 quad_perm:[1,0,3,2] row_mask:0xf bank_mask:0xf
    s_nop 1
    v_max_f32_dpp v18, v18, v18 quad_perm:[2,3,0,1] row_mask:0xf bank_mask:0xf
    s_nop 1
    v_max_f32_dpp v18, v18, v18 row_half_mirror row_mask:0xf bank_mask:0xf
    v_sub_f32 v18, v16, v18
    v_exp_f32 v18, v18
    s_nop 0
    v_mul_f32 v19, v18, v17
    s_nop 1
    v_add_f32_dpp v19, v19, v19 quad_perm:[1,0,3,2] row_mask:0xf bank_mask:0xf
    s_nop 1
    v_add_f32_dpp v19, v19, v19 quad_perm:[2,3,0,1] row_mask:0xf bank_mask:0xf
    s_nop 1
    v_add_f32_dpp v19, v19, v19 row_half_mirror row_mask:0xf bank_mask:0xf
    v_rcp_f32 v19, v19
    s_mov_b32 exec_hi, 0
    v_mul_f32 v18, v18, v19
    ds_write_b32 v25, v18 offset:0
    s_mov_b32 exec_hi, -1
    ds_read_b128 v[28:31], v24 offset:0
    ds_read_b128 v[32:35], v24 offset:64
    s_waitcnt lgkmcnt(0)
L_e4:
    s_cmp_lg_u32 s57, 0
    s_cbranch_scc1 L_e6
    s_bitcmp0_b32 s56, 0
    s_cbranch_scc1 L_e5
    s_cmp_lg_u64 s[48:49], 0
    s_cbranch_scc1 L_e5
    v_mfma_f32_16x16x32_bf16 v[52:55], v[36:39], v[88:91], 0
    v_mfma_f32_16x16x32_bf16 v[52:55], v[40:43], v[104:107], v[52:55]
    v_mfma_f32_16x16x32_bf16 v[56:59], v[36:39], v[92:95], 0
    v_mfma_f32_16x16x32_bf16 v[56:59], v[40:43], v[108:111], v[56:59]
    v_mfma_f32_16x16x32_bf16 v[60:63], v[36:39], v[96:99], 0
    v_mfma_f32_16x16x32_bf16 v[60:63], v[40:43], v[112:115], v[60:63]
    v_mfma_f32_16x16x32_bf16 v[64:67], v[36:39], v[100:103], 0
    v_mfma_f32_16x16x32_bf16 v[64:67], v[40:43], v[116:119], v[64:67]
    s_nop 1
    v_pk_mul_f32 v[52:53], v[52:53], v[28:29]
    v_pk_fma_f32 v[52:53], v[54:55], v[30:31], v[52:53]
    v_add_f32 v52, v52, v53
    ds_write_b32 v20, v52 offset:0
    v_pk_mul_f32 v[56:57], v[56:57], v[28:29]
    v_pk_fma_f32 v[56:57], v[58:59], v[30:31], v[56:57]
    v_add_f32 v56, v56, v57
    ds_write_b32 v20, v56 offset:1280
    v_pk_mul_f32 v[60:61], v[60:61], v[28:29]
    v_pk_fma_f32 v[60:61], v[62:63], v[30:31], v[60:61]
    v_add_f32 v60, v60, v61
    ds_write_b32 v20, v60 offset:2560
    v_pk_mul_f32 v[64:65], v[64:65], v[28:29]
    v_pk_fma_f32 v[64:65], v[66:67], v[30:31], v[64:65]
    v_add_f32 v64, v64, v65
    ds_write_b32 v20, v64 offset:3840
    s_mov_b32 s57, 1
    s_branch L_e6
L_e5:
    s_bitcmp0_b32 s56, 1
    s_cbranch_scc1 L_e6
    s_cmp_lg_u64 s[50:51], 0
    s_cbranch_scc1 L_e6
    v_mfma_f32_16x16x32_bf16 v[68:71], v[44:47], v[88:91], 0
    v_mfma_f32_16x16x32_bf16 v[68:71], v[48:51], v[104:107], v[68:71]
    v_mfma_f32_16x16x32_bf16 v[72:75], v[44:47], v[92:95], 0
    v_mfma_f32_16x16x32_bf16 v[72:75], v[48:51], v[108:111], v[72:75]
    v_mfma_f32_16x16x32_bf16 v[76:79], v[44:47], v[96:99], 0
    v_mfma_f32_16x16x32_bf16 v[76:79], v[48:51], v[112:115], v[76:79]
    v_mfma_f32_16x16x32_bf16 v[80:83], v[44:47], v[100:103], 0
    v_mfma_f32_16x16x32_bf16 v[80:83], v[48:51], v[116:119], v[80:83]
    s_nop 1
    v_pk_mul_f32 v[68:69], v[68:69], v[32:33]
    v_pk_fma_f32 v[68:69], v[70:71], v[34:35], v[68:69]
    v_add_f32 v68, v68, v69
    ds_write_b32 v20, v68 offset:10240
    v_pk_mul_f32 v[72:73], v[72:73], v[32:33]
    v_pk_fma_f32 v[72:73], v[74:75], v[34:35], v[72:73]
    v_add_f32 v72, v72, v73
    ds_write_b32 v20, v72 offset:11520
    v_pk_mul_f32 v[76:77], v[76:77], v[32:33]
    v_pk_fma_f32 v[76:77], v[78:79], v[34:35], v[76:77]
    v_add_f32 v76, v76, v77
    ds_write_b32 v20, v76 offset:12800
    v_pk_mul_f32 v[80:81], v[80:81], v[32:33]
    v_pk_fma_f32 v[80:81], v[82:83], v[34:35], v[80:81]
    v_add_f32 v80, v80, v81
    ds_write_b32 v20, v80 offset:14080
    s_mov_b32 s57, 2
L_e6:
    s_add_u32 s41, s56, s57
    s_cmp_lt_u32 s41, 4
    s_cbranch_scc1 L_e7
    s_cmp_lg_u32 s56, 3
    s_cbranch_scc1 L_e7
    s_cmp_eq_u32 s57, 2
    s_cbranch_scc1 L_tg0
L_tg1:
    s_mov_b64 vcc, s[50:51]
L_tl1:
    s_mov_b64 exec, vcc
    buffer_load_dwordx4 v[44:47], v15, s[16:19], s58 offen offset:2048 sc1
    buffer_load_dwordx4 v[48:51], v15, s[16:19], s58 offen offset:3072 sc1
    s_add_u32 s43, s43, 1
    s_cmp_gt_u32 s43, 400000
    s_waitcnt vmcnt(2)
    s_cbranch_scc1 L_tx1
    v_max3_u32 v23, v44, v45, v46
    v_max3_u32 v23, v23, v47, v48
    v_max3_u32 v23, v23, v49, v50
    v_max_u32 v23, v23, v51
    v_cmp_eq_u32 vcc, -1, v23
    s_cbranch_vccnz L_tl1
L_tx1:
    s_mov_b64 exec, -1
    v_mfma_f32_16x16x32_bf16 v[68:71], v[44:47], v[88:91], 0
    v_mfma_f32_16x16x32_bf16 v[68:71], v[48:51], v[104:107], v[68:71]
    v_mfma_f32_16x16x32_bf16 v[72:75], v[44:47], v[92:95], 0
    v_mfma_f32_16x16x32_bf16 v[72:75], v[48:51], v[108:111], v[72:75]
    v_mfma_f32_16x16x32_bf16 v[76:79], v[44:47], v[96:99], 0
    v_mfma_f32_16x16x32_bf16 v[76:79], v[48:51], v[112:115], v[76:79]
    v_mfma_f32_16x16x32_bf16 v[80:83], v[44:47], v[100:103], 0
    v_mfma_f32_16x16x32_bf16 v[80:83], v[48:51], v[116:119], v[80:83]
    s_nop 1
    v_pk_mul_f32 v[68:69], v[68:69], v[32:33]
    v_pk_fma_f32 v[68:69], v[70:71], v[34:35], v[68:69]
    v_add_f32 v68, v68, v69
    ds_write_b32 v20, v68 offset:10240
    v_pk_mul_f32 v[72:73], v[72:73], v[32:33]
    v_pk_fma_f32 v[72:73], v[74:75], v[34:35], v[72:73]
    v_add_f32 v72, v72, v73
    ds_write_b32 v20, v72 offset:11520
    v_pk_mul_f32 v[76:77], v[76:77], v[32:33]
    v_pk_fma_f32 v[76:77], v[78:79], v[34:35], v[76:77]
    v_add_f32 v76, v76, v77
    ds_write_b32 v20, v76 offset:12800
    v_pk_mul_f32 v[80:81], v[80:81], v[32:33]
    v_pk_fma_f32 v[80:81], v[82:83], v[34:35], v[80:81]
    v_add_f32 v80, v80, v81
    ds_write_b32 v20, v80 offset:14080
    s_branch L_f2
L_tg0:
    s_mov_b64 vcc, s[48:49]
L_tl0:
    s_mov_b64 exec, vcc
    buffer_load_dwordx4 v[36:39], v15, s[16:19], s58 offen offset:0 sc1
    buffer_load_dwordx4 v[40:43], v15, s[16:19], s58 offen offset:1024 sc1
    s_add_u32 s43, s43, 1
    s_cmp_gt_u32 s43, 400000
    s_waitcnt vmcnt(2)
    s_cbranch_scc1 L_tx0
    v_max3_u32 v23, v36, v37, v38
    v_max3_u32 v23, v23, v39, v40
    v_max3_u32 v23, v23, v41, v42
    v_max_u32 v23, v23, v43
    v_cmp_eq_u32 vcc, -1, v23
    s_cbranch_vccnz L_tl0
L_tx0:
    s_mov_b64 exec, -1
    v_mfma_f32_16x16x32_bf16 v[52:55], v[36:39], v[88:91], 0
    v_mfma_f32_16x16x32_bf16 v[52:55], v[40:43], v[104:107], v[52:55]
    v_mfma_f32_16x16x32_bf16 v[56:59], v[36:39], v[92:95], 0
    v_mfma_f32_16x16x32_bf16 v[56:59], v[40:43], v[108:111], v[56:59]
    v_mfma_f32_16x16x32_bf16 v[60:63], v[36:39], v[96:99], 0
    v_mfma_f32_16x16x32_bf16 v[60:63], v[40:43], v[112:115], v[60:63]
    v_mfma_f32_16x16x32_bf16 v[64:67], v[36:39], v[100:103], 0
    v_mfma_f32_16x16x32_bf16 v[64:67], v[40:43], v[116:119], v[64:67]
    s_nop 1
    v_pk_mul_f32 v[52:53], v[52:53], v[28:29]
    v_pk_fma_f32 v[52:53], v[54:55], v[30:31], v[52:53]
    v_add_f32 v52, v52, v53
    ds_write_b32 v20, v52 offset:0
    v_pk_mul_f32 v[56:57], v[56:57], v[28:29]
    v_pk_fma_f32 v[56:57], v[58:59], v[30:31], v[56:57]
    v_add_f32 v56, v56, v57
    ds_write_b32 v20, v56 offset:1280
    v_pk_mul_f32 v[60:61], v[60:61], v[28:29]
    v_pk_fma_f32 v[60:61], v[62:63], v[30:31], v[60:61]
    v_add_f32 v60, v60, v61
    ds_write_b32 v20, v60 offset:2560
    v_pk_mul_f32 v[64:65], v[64:65], v[28:29]
    v_pk_fma_f32 v[64:65], v[66:67], v[30:31], v[64:65]
    v_add_f32 v64, v64, v65
    ds_write_b32 v20, v64 offset:3840
    s_branch L_f2
L_e7:
    s_add_u32 s43, s43, 1
    s_cmp_gt_u32 s43, 400000
    s_waitcnt vmcnt(0)
    s_cbranch_scc1 L_ook
    v_max3_u32 v23, v36, v37, v38
    v_max3_u32 v23, v23, v39, v40
    v_max3_u32 v23, v23, v41, v42
    v_max_u32 v23, v23, v43
    v_max3_u32 v27, v44, v45, v46
    v_max3_u32 v27, v27, v47, v48
    v_max3_u32 v27, v27, v49, v50
    v_max_u32 v27, v27, v51
    v_cmp_eq_u32 s[48:49], -1, v23
    v_cmp_eq_u32 s[50:51], -1, v27
    v_max_u32 v19, v16, v17
    v_cmp_eq_u32 vcc, -1, v19
    s_or_b64 s[4:5], s[48:49], s[50:51]
    s_or_b64 s[4:5], s[4:5], vcc
    s_cbranch_scc0 L_ook
    s_mov_b32 s6, vcc_lo
    s_mov_b64 s[52:53], -1
    s_mov_b64 s[54:55], -1
    s_bcnt1_i32_b32 s41, s6
    s_cmp_le_u32 s41, 6
    s_cbranch_scc1 L_ev
    s_not_b32 s41, s6
    s_pack_ll_b32_b16 s52, s41, s41
    s_pack_hh_b32_b16 s54, s41, s41
    s_mov_b32 s53, s52
    s_mov_b32 s55, s54
    s_sleep 3
    s_branch L_ev
L_ook:
    s_cmp_eq_u32 s57, 1
    s_cbranch_scc1 L_f0
    v_mfma_f32_16x16x32_bf16 v[52:55], v[36:39], v[88:91], 0
    v_mfma_f32_16x16x32_bf16 v[52:55], v[40:43], v[104:107], v[52:55]
    v_mfma_f32_16x16x32_bf16 v[56:59], v[36:39], v[92:95], 0
    v_mfma_f32_16x16x32_bf16 v[56:59], v[40:43], v[108:111], v[56:59]
    v_mfma_f32_16x16x32_bf16 v[60:63], v[36:39], v[96:99], 0
    v_mfma_f32_16x16x32_bf16 v[60:63], v[40:43], v[112:115], v[60:63]
    v_mfma_f32_16x16x32_bf16 v[64:67], v[36:39], v[100:103], 0
    v_mfma_f32_16x16x32_bf16 v[64:67], v[40:43], v[116:119], v[64:67]
    s_cmp_eq_u32 s57, 2
    s_cbranch_scc1 L_f1
L_f0:
    v_mfma_f32_16x16x32_bf16 v[68:71], v[44:47], v[88:91], 0
    v_mfma_f32_16x16x32_bf16 v[68:71], v[48:51], v[104:107], v[68:71]
    v_mfma_f32_16x16x32_bf16 v[72:75], v[44:47], v[92:95], 0
    v_mfma_f32_16x16x32_bf16 v[72:75], v[48:51], v[108:111], v[72:75]
    v_mfma_f32_16x16x32_bf16 v[76:79], v[44:47], v[96:99], 0
    v_mfma_f32_16x16x32_bf16 v[76:79], v[48:51], v[112:115], v[76:79]
    v_mfma_f32_16x16x32_bf16 v[80:83], v[44:47], v[100:103], 0
    v_mfma_f32_16x16x32_bf16 v[80:83], v[48:51], v[116:119], v[80:83]
L_f1:
    s_cmp_eq_u32 s56, 3
    s_cbranch_scc1 L_f1b
    v_mov_b32 v18, v16
    s_nop 1
    v_max_f32_dpp v18, v18, v18 quad_perm:[1,0,3,2] row_mask:0xf bank_mask:0xf
    s_nop 1
    v_max_f32_dpp v18, v18, v18 quad_perm:[2,3,0,1] row_mask:0xf bank_mask:0xf
    s_nop 1
    v_max_f32_dpp v18, v18, v18 row_half_mirror row_mask:0xf bank_mask:0xf
    v_sub_f32 v18, v16, v18
    v_exp_f32 v18, v18
    s_nop 0
    v_mul_f32 v19, v18, v17
    s_nop 1
    v_add_f32_dpp v19, v19, v19 quad_perm:[1,0,3,2] row_mask:0xf bank_mask:0xf
    s_nop 1
    v_add_f32_dpp v19, v19, v19 quad_perm:[2,3,0,1] row_mask:0xf bank_mask:0xf
    s_nop 1
    v_add_f32_dpp v19, v19, v19 row_half_mirror row_mask:0xf bank_mask:0xf
    v_rcp_f32 v19, v19
    s_mov_b32 exec_hi, 0
    v_mul_f32 v18, v18, v19
    ds_write_b32 v25, v18 offset:0
    s_mov_b32 exec_hi, -1
    ds_read_b128 v[28:31], v24 offset:0
    ds_read_b128 v[32:35], v24 offset:64
    s_waitcnt lgkmcnt(0)
L_f1b:
    s_cmp_eq_u32 s57, 1
    s_cbranch_scc1 L_f1d
    v_pk_mul_f32 v[52:53], v[52:53], v[28:29]
    v_pk_fma_f32 v[52:53], v[54:55], v[30:31], v[52:53]
    v_add_f32 v52, v52, v53
    ds_write_b32 v20, v52 offset:0
    v_pk_mul_f32 v[56:57], v[56:57], v[28:29]
    v_pk_fma_f32 v[56:57], v[58:59], v[30:31], v[56:57]
    v_add_f32 v56, v56, v57
    ds_write_b32 v20, v56 offset:1280
    v_pk_mul_f32 v[60:61], v[60:61], v[28:29]
    v_pk_fma_f32 v[60:61], v[62:63], v[30:31], v[60:61]
    v_add_f32 v60, v60, v61
    ds_write_b32 v20, v60 offset:2560
    v_pk_mul_f32 v[64:65], v[64:65], v[28:29]
    v_pk_fma_f32 v[64:65], v[66:67], v[30:31], v[64:65]
    v_add_f32 v64, v64, v65
    ds_write_b32 v20, v64 offset:3840
    s_cmp_eq_u32 s57, 2
    s_cbranch_scc1 L_f2
L_f1d:
    v_pk_mul_f32 v[68:69], v[68:69], v[32:33]
    v_pk_fma_f32 v[68:69], v[70:71], v[34:35], v[68:69]
    v_add_f32 v68, v68, v69
    ds_write_b32 v20, v68 offset:10240
    v_pk_mul_f32 v[72:73], v[72:73], v[32:33]
    v_pk_fma_f32 v[72:73], v[74:75], v[34:35], v[72:73]
    v_add_f32 v72, v72, v73
    ds_write_b32 v20, v72 offset:11520
    v_pk_mul_f32 v[76:77], v[76:77], v[32:33]
    v_pk_fma_f32 v[76:77], v[78:79], v[34:35], v[76:77]
    v_add_f32 v76, v76, v77
    ds_write_b32 v20, v76 offset:12800
    v_pk_mul_f32 v[80:81], v[80:81], v[32:33]
    v_pk_fma_f32 v[80:81], v[82:83], v[34:35], v[80:81]
    v_add_f32 v80, v80, v81
    ds_write_b32 v20, v80 offset:14080
L_f2:
    s_waitcnt lgkmcnt(0)
    s_cmp_lg_u32 s36, 7
    s_cbranch_scc1 L_f3
    s_load_dwordx8 s[64:71], s[16:17], s60 glc
    s_cmp_lg_u32 s36, 7
    s_cbranch_scc1 L_t19
    s_mov_b64 exec, 0x7f
    buffer_store_dword v228, v244, s[16:19], s7 offen sc1
    s_mov_b64 exec, -1
L_t19:
L_f3:
    s_barrier
    s_cmp_lt_u32 s36, 4
    s_cbranch_scc1 L_apred
    s_cmp_ge_u32 s36, 6
    s_cbranch_scc1 L_h2
    ds_read2st64_b32 v[200:201], v236 offset0:0 offset1:1
    ds_read2st64_b32 v[202:203], v236 offset0:2 offset1:3
    ds_read2st64_b32 v[204:205], v236 offset0:4 offset1:5
    ds_read2st64_b32 v[206:207], v236 offset0:6 offset1:7
    v_add_u32 v236, 128, v236
    ds_read2st64_b32 v[208:209], v236 offset0:0 offset1:1
    ds_read2st64_b32 v[210:211], v236 offset0:2 offset1:3
    ds_read2st64_b32 v[212:213], v236 offset0:4 offset1:5
    ds_read2st64_b32 v[214:215], v236 offset0:6 offset1:7
    s_waitcnt lgkmcnt(0)
    v_pk_add_f32 v[200:201], v[200:201], v[202:203]
    v_pk_add_f32 v[204:205], v[204:205], v[206:207]
    v_pk_add_f32 v[208:209], v[208:209], v[210:211]
    v_pk_add_f32 v[212:213], v[212:213], v[214:215]
    v_pk_add_f32 v[200:201], v[200:201], v[204:205]
    v_pk_add_f32 v[208:209], v[208:209], v[212:213]
    v_add_f32 v200, v200, v201
    v_add_f32 v208, v208, v209
    v_mov_b32 v232, v200
    v_mov_b32 v233, v208
    s_branch L_h2
L_apred:
    ds_read_b128 v[200:203], v21 offset:9728
    ds_read_b128 v[204:207], v21 offset:9744
    ds_read_b128 v[208:211], v21 offset:9760
    ds_read_b128 v[212:215], v21 offset:9776
    s_waitcnt lgkmcnt(2)
    v_pk_add_f32 v[200:201], v[200:201], v[202:203]
    v_pk_add_f32 v[204:205], v[204:205], v[206:207]
    v_pk_add_f32 v[200:201], v[200:201], v[204:205]
    s_waitcnt lgkmcnt(0)
    v_pk_add_f32 v[208:209], v[208:209], v[210:211]
    v_pk_add_f32 v[212:213], v[212:213], v[214:215]
    v_pk_add_f32 v[200:201], v[200:201], v[208:209]
    v_pk_add_f32 v[200:201], v[200:201], v[212:213]
    v_add_f32 v200, v200, v201
    buffer_store_dword v200, v22, s[16:19], s42 offen sc1
L_h2:
    s_mov_b64 exec, -1
    s_cmp_eq_u32 s38, 3
    s_cbranch_scc1 L_fin
    s_mov_b32 s43, 0
    s_cmp_eq_u32 s36, 7
    s_cbranch_scc1 L_h7
L_hpoll:
    ds_read_b32 v18, v26 offset:7620
    s_add_u32 s43, s43, 1
    s_cmp_gt_u32 s43, 3200000
    s_cbranch_scc1 L_apoll0
    s_waitcnt lgkmcnt(0)
    v_readfirstlane_b32 s8, v18
    s_andn2_b32 s9, s8, s3
    s_cbranch_scc0 L_hpoll
    s_bitcmp0_b32 s9, 0
    s_cbranch_scc1 L_t20
    buffer_load_dwordx4 v[168:171], v242, s[16:19], s20 offen sc1
L_t20:
    s_bitcmp0_b32 s9, 1
    s_cbranch_scc1 L_t21
    buffer_load_dwordx4 v[172:175], v242, s[16:19], s21 offen sc1
L_t21:
    s_bitcmp0_b32 s9, 2
    s_cbranch_scc1 L_t22
    buffer_load_dwordx4 v[176:179], v242, s[16:19], s22 offen sc1
L_t22:
    s_bitcmp0_b32 s9, 3
    s_cbranch_scc1 L_t23
    buffer_load_dwordx4 v[180:183], v242, s[16:19], s23 offen sc1
L_t23:
    s_bitcmp0_b32 s9, 4
    s_cbranch_scc1 L_t24
    buffer_load_dwordx4 v[184:187], v242, s[16:19], s24 offen sc1
L_t24:
    s_bitcmp0_b32 s9, 5
    s_cbranch_scc1 L_t25
    buffer_load_dwordx4 v[188:191], v242, s[16:19], s25 offen sc1
L_t25:
    s_bitcmp0_b32 s9, 6
    s_cbranch_scc1 L_t26
    buffer_load_dwordx4 v[192:195], v242, s[16:19], s26 offen sc1
L_t26:
    s_bitcmp0_b32 s9, 7
    s_cbranch_scc1 L_t27
    buffer_load_dwordx4 v[196:199], v242, s[16:19], s27 offen sc1
L_t27:
    s_mov_b32 s3, s8
    s_cmp_lg_u32 s8, 0xff
    s_cbranch_scc1 L_hpoll
    s_branch L_achk
L_h7:
    s_load_dwordx8 s[64:71], s[16:17], s60 glc
    s_add_u32 s43, s43, 1
    s_cmp_gt_u32 s43, 1600000
    s_cbranch_scc1 L_apoll0
    s_waitcnt lgkmcnt(4)
    s_mov_b32 s8, 0
    s_cmp_eq_u32 s71, s39
    s_addc_u32 s8, s8, s8
    s_cmp_eq_u32 s70, s39
    s_addc_u32 s8, s8, s8
    s_cmp_eq_u32 s69, s39
    s_addc_u32 s8, s8, s8
    s_cmp_eq_u32 s68, s39
    s_addc_u32 s8, s8, s8
    s_cmp_eq_u32 s67, s39
    s_addc_u32 s8, s8, s8
    s_cmp_eq_u32 s66, s39
    s_addc_u32 s8, s8, s8
    s_cmp_eq_u32 s65, s39
    s_addc_u32 s8, s8, s8
    s_cmp_eq_u32 s64, s39
    s_addc_u32 s8, s8, s8
    s_or_b32 s8, s8, s3
    s_cmp_eq_u32 s8, s3
    s_cbranch_scc1 L_h7
    v_mov_b32 v18, s8
    ds_write_b32 v26, v18 offset:7620
    s_andn2_b32 s9, s8, s3
    s_bitcmp0_b32 s9, 0
    s_cbranch_scc1 L_t28
    buffer_load_dwordx4 v[168:171], v242, s[16:19], s20 offen sc1
L_t28:
    s_bitcmp0_b32 s9, 1
    s_cbranch_scc1 L_t29
    buffer_load_dwordx4 v[172:175], v242, s[16:19], s21 offen sc1
L_t29:
    s_bitcmp0_b32 s9, 2
    s_cbranch_scc1 L_t30
    buffer_load_dwordx4 v[176:179], v242, s[16:19], s22 offen sc1
L_t30:
    s_bitcmp0_b32 s9, 3
    s_cbranch_scc1 L_t31
    buffer_load_dwordx4 v[180:183], v242, s[16:19], s23 offen sc1
L_t31:
    s_bitcmp0_b32 s9, 4
    s_cbranch_scc1 L_t32
    buffer_load_dwordx4 v[184:187], v242, s[16:19], s24 offen sc1
L_t32:
    s_bitcmp0_b32 s9, 5
    s_cbranch_scc1 L_t33
    buffer_load_dwordx4 v[188:191], v242, s[16:19], s25 offen sc1
L_t33:
    s_bitcmp0_b32 s9, 6
    s_cbranch_scc1 L_t34
    buffer_load_dwordx4 v[192:195], v242, s[16:19], s26 offen sc1
L_t34:
    s_bitcmp0_b32 s9, 7
    s_cbranch_scc1 L_t35
    buffer_load_dwordx4 v[196:199], v242, s[16:19], s27 offen sc1
L_t35:
    s_mov_b32 s3, s8
    s_cmp_lg_u32 s8, 0xff
    s_cbranch_scc1 L_h7
    s_branch L_achk
L_apoll0:
    s_mov_b32 s43, 2800000
L_apoll:
    s_mov_b32 s13, 3200000
    s_waitcnt vmcnt(0)
    v_max3_u32 v23, v168, v169, v170
    v_max_u32 v23, v23, v171
    v_cmp_eq_u32 vcc, -1, v23
    s_cbranch_vccz L_t36
    s_mov_b64 exec, vcc
    buffer_load_dwordx4 v[168:171], v242, s[16:19], s20 offen sc1
    s_mov_b64 exec, -1
    s_mov_b32 s13, 0
L_t36:
    v_max3_u32 v23, v172, v173, v174
    v_max_u32 v23, v23, v175
    v_cmp_eq_u32 vcc, -1, v23
    s_cbranch_vccz L_t37
    s_mov_b64 exec, vcc
    buffer_load_dwordx4 v[172:175], v242, s[16:19], s21 offen sc1
    s_mov_b64 exec, -1
    s_mov_b32 s13, 0
L_t37:
    v_max3_u32 v23, v176, v177, v178
    v_max_u32 v23, v23, v179
    v_cmp_eq_u32 vcc, -1, v23
    s_cbranch_vccz L_t38
    s_mov_b64 exec, vcc
    buffer_load_dwordx4 v[176:179], v242, s[16:19], s22 offen sc1
    s_mov_b64 exec, -1
    s_mov_b32 s13, 0
L_t38:
    v_max3_u32 v23, v180, v181, v182
    v_max_u32 v23, v23, v183
    v_cmp_eq_u32 vcc, -1, v23
    s_cbranch_vccz L_t39
    s_mov_b64 exec, vcc
    buffer_load_dwordx4 v[180:183], v242, s[16:19], s23 offen sc1
    s_mov_b64 exec, -1
    s_mov_b32 s13, 0
L_t39:
    v_max3_u32 v23, v184, v185, v186
    v_max_u32 v23, v23, v187
    v_cmp_eq_u32 vcc, -1, v23
    s_cbranch_vccz L_t40
    s_mov_b64 exec, vcc
    buffer_load_dwordx4 v[184:187], v242, s[16:19], s24 offen sc1
    s_mov_b64 exec, -1
    s_mov_b32 s13, 0
L_t40:
    v_max3_u32 v23, v188, v189, v190
    v_max_u32 v23, v23, v191
    v_cmp_eq_u32 vcc, -1, v23
    s_cbranch_vccz L_t41
    s_mov_b64 exec, vcc
    buffer_load_dwordx4 v[188:191], v242, s[16:19], s25 offen sc1
    s_mov_b64 exec, -1
    s_mov_b32 s13, 0
L_t41:
    v_max3_u32 v23, v192, v193, v194
    v_max_u32 v23, v23, v195
    v_cmp_eq_u32 vcc, -1, v23
    s_cbranch_vccz L_t42
    s_mov_b64 exec, vcc
    buffer_load_dwordx4 v[192:195], v242, s[16:19], s26 offen sc1
    s_mov_b64 exec, -1
    s_mov_b32 s13, 0
L_t42:
    v_max3_u32 v23, v196, v197, v198
    v_max_u32 v23, v23, v199
    v_cmp_eq_u32 vcc, -1, v23
    s_cbranch_vccz L_t43
    s_mov_b64 exec, vcc
    buffer_load_dwordx4 v[196:199], v242, s[16:19], s27 offen sc1
    s_mov_b64 exec, -1
    s_mov_b32 s13, 0
L_t43:
    s_add_u32 s43, s43, s13
L_achk:
    s_lshl_b32 s42, s44, 6
    s_lshl_b32 s41, s36, 14
    s_add_u32 s42, s42, s41
    s_add_u32 s42, s42, 1048576
    s_mov_b32 s7, 0xffffff00
    s_lshr_b32 s9, s36, 1
    s_add_u32 s43, s43, 1
    s_cmp_gt_u32 s43, 3200000
    s_cselect_b64 s[4:5], 0, -1
    s_waitcnt vmcnt(0) lgkmcnt(0)
    v_pk_add_f32 v[200:201], v[168:169], v[172:173]
    v_pk_add_f32 v[202:203], v[170:171], v[174:175]
    v_pk_add_f32 v[204:205], v[176:177], v[180:181]
    v_pk_add_f32 v[206:207], v[178:179], v[182:183]
    v_pk_add_f32 v[208:209], v[184:185], v[188:189]
    v_pk_add_f32 v[210:211], v[186:187], v[190:191]
    v_pk_add_f32 v[212:213], v[192:193], v[196:197]
    v_pk_add_f32 v[214:215], v[194:195], v[198:199]
    v_pk_add_f32 v[200:201], v[200:201], v[220:221]
    v_pk_add_f32 v[202:203], v[202:203], v[222:223]
    v_pk_add_f32 v[208:209], v[208:209], v[212:213]
    v_pk_add_f32 v[210:211], v[210:211], v[214:215]
    v_pk_add_f32 v[200:201], v[200:201], v[204:205]
    v_pk_add_f32 v[202:203], v[202:203], v[206:207]
    v_pk_add_f32 v[200:201], v[200:201], v[208:209]
    v_pk_add_f32 v[202:203], v[202:203], v[210:211]
    v_cvt_pk_bf16_f32 v204, v200, v201
    v_cvt_pk_bf16_f32 v205, v202, v203
    ds_write_b64 v234, v[204:205]
    ds_read_b128 v[56:59], v248 offset:0
    ds_read_b128 v[60:63], v249 offset:0
    ds_read_b128 v[64:67], v250 offset:0
    ds_read_b128 v[68:71], v251 offset:0
    ds_read_b128 v[72:75], v248 offset:64
    ds_read_b128 v[76:79], v249 offset:64
    ds_read_b128 v[80:83], v250 offset:64
    ds_read_b128 v[84:87], v251 offset:64
    v_lshlrev_b32 v200, 16, v204
    v_and_b32 v201, 0xffff0000, v204
    v_lshlrev_b32 v202, 16, v205
    v_and_b32 v203, 0xffff0000, v205
    v_pk_add_f32 v[208:209], v[200:201], v[202:203]
    v_pk_mul_f32 v[210:211], v[200:201], v[200:201]
    v_add_f32 v206, v208, v209
    v_pk_fma_f32 v[210:211], v[202:203], v[202:203], v[210:211]
    v_cmp_u_f32 vcc, v206, v206
    v_add_f32 v207, v210, v211
    s_and_b64 vcc, vcc, s[4:5]
    s_cbranch_scc1 L_apoll
    s_waitcnt lgkmcnt(7)
    v_mfma_f32_16x16x32_bf16 v[52:55], v[120:123], v[56:59], 0
    v_add_f32_dpp v206, v206, v206 quad_perm:[1,0,3,2] row_mask:0xf bank_mask:0xf
    v_add_f32_dpp v207, v207, v207 quad_perm:[1,0,3,2] row_mask:0xf bank_mask:0xf
    s_waitcnt lgkmcnt(6)
    v_mfma_f32_16x16x32_bf16 v[52:55], v[124:127], v[60:63], v[52:55]
    v_add_f32_dpp v206, v206, v206 quad_perm:[2,3,0,1] row_mask:0xf bank_mask:0xf
    v_add_f32_dpp v207, v207, v207 quad_perm:[2,3,0,1] row_mask:0xf bank_mask:0xf
    s_waitcnt lgkmcnt(5)
    v_mfma_f32_16x16x32_bf16 v[52:55], v[128:131], v[64:67], v[52:55]
    v_add_f32_dpp v206, v206, v206 row_half_mirror row_mask:0xf bank_mask:0xf
    v_add_f32_dpp v207, v207, v207 row_half_mirror row_mask:0xf bank_mask:0xf
    s_waitcnt lgkmcnt(4)
    v_mfma_f32_16x16x32_bf16 v[52:55], v[132:135], v[68:71], v[52:55]
    v_add_f32_dpp v206, v206, v206 row_mirror row_mask:0xf bank_mask:0xf
    v_add_f32_dpp v207, v207, v207 row_mirror row_mask:0xf bank_mask:0xf
    s_waitcnt lgkmcnt(3)
    v_mfma_f32_16x16x32_bf16 v[52:55], v[136:139], v[72:75], v[52:55]
    s_waitcnt lgkmcnt(2)
    v_mfma_f32_16x16x32_bf16 v[52:55], v[140:143], v[76:79], v[52:55]
    s_waitcnt lgkmcnt(1)
    v_mfma_f32_16x16x32_bf16 v[52:55], v[144:147], v[80:83], v[52:55]
    s_waitcnt lgkmcnt(0)
    v_mfma_f32_16x16x32_bf16 v[52:55], v[148:151], v[84:87], v[52:55]
    s_mov_b32 exec_lo, 0x00010001
    s_mov_b32 exec_hi, 0x00010001
    ds_write_b64 v238, v[206:207] offset:38400
    s_mov_b64 exec, -1
    s_nop 3
    ds_write_b128 v229, v[52:55] offset:30208
    s_cmp_lg_u32 s9, 2
    s_waitcnt lgkmcnt(0)
    s_barrier
    s_cbranch_scc1 L_act_skip
    ds_read_b128 v[184:187], v239 offset:38400
    ds_read_b128 v[188:191], v239 offset:38416
    ds_read_b128 v[192:195], v239 offset:38432
    ds_read_b128 v[196:199], v239 offset:38448
    ds_read2st64_b32 v[168:169], v237 offset0:0 offset1:4
    ds_read2st64_b32 v[170:171], v237 offset0:8 offset1:12
    ds_read2st64_b32 v[172:173], v237 offset0:16 offset1:20
    ds_read2st64_b32 v[174:175], v237 offset0:24 offset1:28
    ds_read2st64_b32 v[176:177], v235 offset0:0 offset1:4
    ds_read2st64_b32 v[178:179], v235 offset0:8 offset1:12
    ds_read2st64_b32 v[180:181], v235 offset0:16 offset1:20
    ds_read2st64_b32 v[182:183], v235 offset0:24 offset1:28
    s_waitcnt lgkmcnt(10)
    v_pk_add_f32 v[184:185], v[184:185], v[186:187]
    v_pk_add_f32 v[188:189], v[188:189], v[190:191]
    s_waitcnt lgkmcnt(8)
    v_pk_add_f32 v[192:193], v[192:193], v[194:195]
    v_pk_add_f32 v[196:197], v[196:197], v[198:199]
    v_pk_add_f32 v[184:185], v[184:185], v[188:189]
    v_pk_add_f32 v[192:193], v[192:193], v[196:197]
    v_pk_add_f32 v[184:185], v[184:185], v[192:193]
    v_mul_f32 v184, 0x3b000000, v184
    v_mul_f32 v185, 0x3b000000, v185
    v_fma_f32 v185, -v184, v184, v185
    v_max_f32 v185, 0, v185
    v_add_f32 v185, 0x3727c5ac, v185
    v_rsq_f32 v185, v185
    s_waitcnt lgkmcnt(4)
    v_pk_add_f32 v[168:169], v[168:169], v[170:171]
    v_pk_add_f32 v[172:173], v[172:173], v[174:175]
    v_pk_add_f32 v[168:169], v[168:169], v[172:173]
    v_add_f32 v168, v168, v169
    v_fma_f32 v168, -v184, v232, v168
    v_mul_f32 v168, v168, v185
    v_mul_f32 v169, 0xbfb8aa3b, v168
    v_exp_f32 v169, v169
    s_waitcnt lgkmcnt(0)
    v_pk_add_f32 v[176:177], v[176:177], v[178:179]
    v_add_f32 v169, 1.0, v169
    v_pk_add_f32 v[180:181], v[180:181], v[182:183]
    v_rcp_f32 v169, v169
    v_pk_add_f32 v[176:177], v[176:177], v[180:181]
    v_mul_f32 v168, v168, v185
    v_add_f32 v176, v176, v177
    v_mul_f32 v168, v168, v169
    v_fma_f32 v176, -v184, v233, v176
    v_mul_f32 v176, v176, v168
    v_cvt_pk_bf16_f32 v176, v176, v176
    ds_write_b16 v240, v176 offset:7168
    s_waitcnt lgkmcnt(0)
L_act_skip:
    s_cmp_lg_u32 s36, 7
    s_cbranch_scc1 L_t44
    s_mov_b64 exec, 0x7ffff
    buffer_store_dword v228, v244, s[16:19], s62 offen offset:32 sc1
    s_mov_b64 exec, -1
L_t44:
    s_barrier
    ds_read_b128 v[36:39], v224 offset:7168
    ds_read_b128 v[40:43], v225 offset:7168
    ds_read_b128 v[44:47], v226 offset:7168
    ds_read_b128 v[48:51], v227 offset:7168
    s_waitcnt lgkmcnt(3)
    v_mfma_f32_16x16x32_bf16 v[52:55], v[152:155], v[36:39], 0
    s_waitcnt lgkmcnt(2)
    v_mfma_f32_16x16x32_bf16 v[52:55], v[156:159], v[40:43], v[52:55]
    s_waitcnt lgkmcnt(1)
    v_mfma_f32_16x16x32_bf16 v[52:55], v[160:163], v[44:47], v[52:55]
    s_waitcnt lgkmcnt(0)
    v_mfma_f32_16x16x32_bf16 v[52:55], v[164:167], v[48:51], v[52:55]
    s_nop 7
    v_and_or_b32 v52, v52, s7, v216
    v_and_or_b32 v53, v53, s7, v217
    v_and_or_b32 v54, v54, s7, v218
    v_and_or_b32 v55, v55, s7, v219
    buffer_store_dwordx4 v[52:55], v241, s[16:19], s42 offen sc1
    s_branch L_fin
L_codeend:

.section .rodata,"a"
.p2align 6
.amdhsa_kernel sequential_preLN__gqa_block_cached__swiglu_ffn__decode_kernel
  .amdhsa_next_free_vgpr 252
  .amdhsa_next_free_sgpr 102
  .amdhsa_accum_offset 252
  .amdhsa_group_segment_fixed_size 0
  .amdhsa_kernarg_size 96
  .amdhsa_user_sgpr_count 2
  .amdhsa_user_sgpr_kernarg_segment_ptr 1
  .amdhsa_system_sgpr_workgroup_id_x 1
.end_amdhsa_kernel
```
